```python
import torch

def _softmax(x, axis=-1):
    return torch.softmax(x, dim=axis)

def _gelu(x):
    return torch.nn.functional.gelu(x, approximate='tanh')

def _silu(x):
    return torch.nn.functional.silu(x)

def _sigmoid(x):
    return torch.sigmoid(x)

def _layernorm(x, axis=-1, eps=1e-05):
    m = x.mean(dim=axis, keepdim=True)
    v = x.var(dim=axis, keepdim=True, unbiased=False)
    return (x - m) / torch.sqrt(v + eps)

def _scatter_add(tgt, idx, src, axis=0):
    return tgt.clone().index_add_(axis, idx, src)

def _segment_sum(src, seg, n):
    out = torch.zeros((n,) + src.shape[1:], dtype=src.dtype)
    return out.index_add_(0, seg, src)

def _pad(x, pw):
    flat = tuple((v for pair in reversed(pw) for v in pair))
    return torch.nn.functional.pad(x, flat)
kernel_name = 'sequential_preLN__linear_kernel_hedgehog__mixer_gmlp__prompt'

def setup_inputs():

    _w = lambda a: (lambda t: t.to(torch.bfloat16) if t.is_floating_point() else t)(torch.as_tensor(a))

    def _A_setup():
        B, S, D, H = (1, 2048, 512, 32)
        Dh = D // H
        return {'x': _w((lambda *s: torch.randn(*s, dtype=torch.bfloat16) * 0.05)(B, S, D)), 'wqkv': _w((lambda *s: torch.randn(*s, dtype=torch.bfloat16) * 0.2)(D, 3 * D)), 'w_phi': _w((lambda *s: torch.randn(*s, dtype=torch.bfloat16) * 0.2)(H, Dh, Dh) * Dh ** (-0.5)), 'wo': _w((lambda *s: torch.randn(*s, dtype=torch.bfloat16) * 0.05)(D, D))}
    _A_in = _A_setup()

    def _B_setup():
        B, S, D, F = (1, 2048, 512, 1376)
        Fh = F // 2
        return {'x': _w((lambda *s: torch.randn(*s, dtype=torch.bfloat16) * 0.05)(B, S, D)), 'w_in': _w((lambda *s: torch.randn(*s, dtype=torch.bfloat16) * 0.2)(D, 2 * Fh)), 'w_sp': _w(0.01 * (lambda *s: torch.randn(*s, dtype=torch.bfloat16) * 0.2)(S, S)), 'b_sp': _w(1.0 + 0.01 * (lambda *s: torch.randn(*s, dtype=torch.bfloat16) * 0.05)(S)), 'w_out': _w((lambda *s: torch.randn(*s, dtype=torch.bfloat16) * 0.05)(Fh, D))}
    _B_in = _B_setup()
    return {'A_x': _A_in['x'], 'A_wqkv': _A_in['wqkv'], 'A_w_phi': _A_in['w_phi'], 'A_wo': _A_in['wo'], 'B_x': _B_in['x'], 'B_w_in': _B_in['w_in'], 'B_w_sp': _B_in['w_sp'], 'B_b_sp': _B_in['b_sp'], 'B_w_out': _B_in['w_out']}

def reference(A_x, A_wqkv, A_w_phi, A_wo, B_x, B_w_in, B_w_sp, B_b_sp, B_w_out):

    def _A_ref(x, wqkv, w_phi, wo):
        B, S, D = x.shape
        H = 32
        Dh = D // H
        qkv = (lambda x, *d: x.permute(*d))((x @ wqkv).reshape(B, S, 3, H, Dh), 2, 0, 3, 1, 4)
        q, k, v = (qkv[0], qkv[1], qkv[2])
        pq = torch.einsum('bhsd,hdf->bhsf', q, w_phi)
        pk = torch.einsum('bhsd,hdf->bhsf', k, w_phi)
        phi_q = torch.concatenate([_softmax(pq, axis=-1), _softmax(-pq, axis=-1)], axis=-1)
        phi_k = torch.concatenate([_softmax(pk, axis=-1), _softmax(-pk, axis=-1)], axis=-1)
        kv = torch.einsum('bhsf,bhsd->bhfd', phi_k, v)
        z = torch.einsum('bhsf->bhf', phi_k)
        num = torch.einsum('bhqf,bhfd->bhqd', phi_q, kv)
        den = torch.einsum('bhqf,bhf->bhq', phi_q, z)[..., None] + 1e-06
        o = num / den
        return (lambda x, *d: x.permute(*d))(o, 0, 2, 1, 3).reshape(B, S, D) @ wo

    def _B_ref(x, w_in, w_sp, b_sp, w_out):
        B, S, D = x.shape
        F = w_in.shape[-1]
        Fh = F // 2
        z = _gelu(torch.einsum('bsd,df->bsf', x, w_in))
        z1 = z[..., :Fh].clone()
        z2 = _layernorm(z[..., Fh:], axis=-1)
        g = torch.einsum('ts,bsf->btf', w_sp, z2) + b_sp[None, :, None]
        return torch.einsum('bsf,fd->bsd', z1 * g, w_out)
    x = A_x
    h = x + _A_ref(_layernorm(x, axis=-1), A_wqkv, A_w_phi, A_wo)
    h2 = h + _B_ref(_layernorm(h, axis=-1), B_w_in, B_w_sp, B_b_sp, B_w_out)
    return h2
```

```asm
; @launch kernel=ka_kernel grid=(256,1,1) block=(768,1,1) lds=163840
; @launch kernel=kb1_kernel grid=(256,1,1) block=(512,1,1) lds=135232
; @launch kernel=kb2_kernel grid=(256,1,1) block=(768,1,1) lds=163840
; @launch kernel=kc1_kernel grid=(256,1,1) block=(512,1,1) lds=163840
; @launch kernel=kc2_kernel grid=(256,1,1) block=(512,1,1) lds=159744
.amdgcn_target "amdgcn-amd-amdhsa--gfx950"
.text
.globl ka_kernel
.p2align 8
.type ka_kernel,@function
ka_kernel:
  s_cmp_ge_u32 s2, 256
  s_cbranch_scc1 ka_kernel_end
  s_load_dwordx16 s[8:23], s[0:1], 0
  s_load_dwordx8 s[24:31], s[0:1], 64
  s_and_b32 s3, s2, 7
  s_lshr_b32 s4, s2, 3
  s_lshl_b32 s5, s3, 2
  s_lshr_b32 s6, s4, 3
  s_add_u32 s5, s5, s6
  s_and_b32 s6, s4, 7
  v_lshrrev_b32 v1, 6, v0
  v_and_b32 v2, 63, v0
  v_readfirstlane_b32 s7, v1
  v_and_b32 v3, 31, v0
  v_bfe_u32 v4, v0, 5, 1
  s_waitcnt lgkmcnt(0)
  s_lshr_b32 s68, s2, 3
  s_cmp_ge_u32 s68, 6
  s_cbranch_scc1 ka_kernel_ncp
  s_cmp_lg_u32 s7, 8
  s_cbranch_scc1 ka_kernel_ncp
  s_getpc_b64 s[60:61]
ka_kernel_pc:
  s_sub_u32 s60, s60, ka_kernel_pc-ka_kernel
  s_subb_u32 s61, s61, 0
  s_lshl_b32 s68, s68, 12
  v_lshlrev_b32 v140, 6, v2
  v_add_u32 v140, s68, v140
  v_min_u32 v140, kc2_kernel_end-ka_kernel, v140
  global_load_dword v141, v140, s[60:61]
ka_kernel_ncp:
  s_mov_b32 s32, s8
  s_mov_b32 s33, s9
  s_mov_b32 s34, 2097152
  s_mov_b32 s35, 0x00020000
  s_mov_b32 s36, s10
  s_mov_b32 s37, s11
  s_mov_b32 s38, 1572864
  s_mov_b32 s39, 0x00020000
  s_mov_b32 s40, s30
  s_mov_b32 s41, s31
  s_mov_b32 s42, 268435456
  s_mov_b32 s43, 0x00020000
  s_mov_b32 s44, s12
  s_mov_b32 s45, s13
  s_mov_b32 s46, 16384
  s_mov_b32 s47, 0x00020000
  s_mov_b32 s64, s28
  s_mov_b32 s65, s29
  s_mov_b32 s66, 256
  s_mov_b32 s67, 0x00020000
  s_cmp_ge_u32 s7, 6
  s_cselect_b32 s49, 1, 0
  s_mul_i32 s48, s49, 6
  s_sub_u32 s48, s7, s48
  s_lshr_b32 s51, s7, 2
  s_lshl_b32 s50, s6, 7
  s_lshl_b32 s52, s5, 16
  s_add_u32 s52, s52, 0
  v_lshrrev_b32 v5, 3, v0
  v_and_b32 v6, 7, v0
  v_lshlrev_b32 v7, 10, v5
  v_lshl_add_u32 v7, v6, 4, v7
  s_cmp_ge_u32 s7, 8
  s_cbranch_scc1 ka_kernel_nox
  buffer_load_dwordx4 v[16:19], v7, s[32:35], s52 offen offset:0
  buffer_load_dwordx4 v[20:23], v7, s[32:35], s52 offen offset:128
  buffer_load_dwordx4 v[24:27], v7, s[32:35], s52 offen offset:256
  buffer_load_dwordx4 v[28:31], v7, s[32:35], s52 offen offset:384
  buffer_load_dwordx4 v[32:35], v7, s[32:35], s52 offen offset:512
  buffer_load_dwordx4 v[36:39], v7, s[32:35], s52 offen offset:640
  buffer_load_dwordx4 v[40:43], v7, s[32:35], s52 offen offset:768
  buffer_load_dwordx4 v[44:47], v7, s[32:35], s52 offen offset:896
ka_kernel_nox:
  s_and_b32 s53, s7, 3
  s_lshl_b32 s54, s53, 11
  s_lshl_b32 s53, s53, 4
  v_lshrrev_b32 v8, 3, v2
  v_add_u32 v8, s53, v8
  v_mul_u32_u24 v8, 3072, v8
  v_bfe_u32 v9, v2, 4, 1
  v_lshlrev_b32 v9, 2, v9
  v_and_b32 v10, 7, v2
  v_xor_b32 v9, v9, v10
  v_lshl_add_u32 v8, v9, 4, v8
  v_add_u32 v8, s50, v8
  v_add_u32 v9, 23552, v8
  s_add_u32 s54, s54, 65536
  s_cmp_lg_u32 s5, 0
  s_cbranch_scc1 ka_kernel_nz
  s_cmp_lt_u32 s7, 8
  s_cbranch_scc1 ka_kernel_nz
  s_lshl_b32 s56, s6, 2
  s_add_u32 s56, s56, s7
  s_sub_u32 s56, s56, 8
  s_mul_i32 s56, s56, 2176
  v_lshlrev_b32 v10, 4, v2
  v_mov_b32 v12, 0
  v_mov_b32 v13, 0
  v_mov_b32 v14, 0
  v_mov_b32 v15, 0
  buffer_store_dwordx4 v[12:15], v10, s[40:43], s56 offen offset:0 sc0 sc1
  buffer_store_dwordx4 v[12:15], v10, s[40:43], s56 offen offset:1024 sc0 sc1
  buffer_store_dwordx4 v[12:15], v10, s[40:43], s56 offen offset:1152 sc0 sc1
ka_kernel_nz:
  s_cmp_lt_u32 s7, 8
  s_cbranch_scc1 ka_kernel_d1
  s_add_u32 m0, s54, 0
  s_mov_b32 s55, 0
  buffer_load_dwordx4 v8, s[36:39], s55 offen lds
  buffer_load_dwordx4 v9, s[36:39], s55 offen offset:1024 lds
  s_add_u32 m0, s54, 8192
  s_mov_b32 s55, 1024
  buffer_load_dwordx4 v8, s[36:39], s55 offen lds
  buffer_load_dwordx4 v9, s[36:39], s55 offen offset:1024 lds
  s_add_u32 m0, s54, 16384
  s_mov_b32 s55, 2048
  buffer_load_dwordx4 v8, s[36:39], s55 offen lds
  buffer_load_dwordx4 v9, s[36:39], s55 offen offset:1024 lds
  s_add_u32 m0, s54, 24576
  s_mov_b32 s55, 196608
  buffer_load_dwordx4 v8, s[36:39], s55 offen lds
  buffer_load_dwordx4 v9, s[36:39], s55 offen offset:1024 lds
  s_add_u32 m0, s54, 32768
  s_mov_b32 s55, 197632
  buffer_load_dwordx4 v8, s[36:39], s55 offen lds
  buffer_load_dwordx4 v9, s[36:39], s55 offen offset:1024 lds
  s_add_u32 m0, s54, 40960
  s_mov_b32 s55, 198656
  buffer_load_dwordx4 v8, s[36:39], s55 offen lds
  buffer_load_dwordx4 v9, s[36:39], s55 offen offset:1024 lds
ka_kernel_d1:
  s_mov_b32 s60, s10
  s_mov_b32 s61, s11
  s_mov_b32 s62, 1572864
  s_mov_b32 s63, 0x00020000
  s_sub_u32 s68, s7, 8
  s_cmp_ge_u32 s68, 2
  s_cbranch_scc1 pf1
  s_lshl_b32 s68, s68, 12
  v_lshlrev_b32 v140, 6, v2
  v_add_u32 v140, s68, v140
  s_mul_i32 s69, s2, 6144
  buffer_load_dword v141, v140, s[60:63], s69 offen
pf1:
  s_cmp_lg_u32 s5, 0
  s_cbranch_scc1 ka_kernel_nf
  s_cmp_lt_u32 s7, 8
  s_cbranch_scc1 ka_kernel_nf
  s_waitcnt vmcnt(0)
  s_lshl_b32 s56, s6, 2
  v_mov_b32 v12, 1
  v_mov_b32 v13, 0
  s_mov_b64 exec, 1
  buffer_atomic_add v12, v13, s[64:67], s56 offen sc1
  s_mov_b64 exec, -1
ka_kernel_nf:
  s_cmp_ge_u32 s7, 8
  s_cbranch_scc1 ka_kernel_noln
  s_waitcnt vmcnt(0)
  v_lshlrev_b32 v48, 16, v16
  v_and_b32 v49, 0xffff0000, v16
  v_lshlrev_b32 v50, 16, v17
  v_and_b32 v51, 0xffff0000, v17
  v_lshlrev_b32 v52, 16, v18
  v_and_b32 v53, 0xffff0000, v18
  v_lshlrev_b32 v54, 16, v19
  v_and_b32 v55, 0xffff0000, v19
  v_lshlrev_b32 v56, 16, v20
  v_and_b32 v57, 0xffff0000, v20
  v_lshlrev_b32 v58, 16, v21
  v_and_b32 v59, 0xffff0000, v21
  v_lshlrev_b32 v60, 16, v22
  v_and_b32 v61, 0xffff0000, v22
  v_lshlrev_b32 v62, 16, v23
  v_and_b32 v63, 0xffff0000, v23
  v_lshlrev_b32 v64, 16, v24
  v_and_b32 v65, 0xffff0000, v24
  v_lshlrev_b32 v66, 16, v25
  v_and_b32 v67, 0xffff0000, v25
  v_lshlrev_b32 v68, 16, v26
  v_and_b32 v69, 0xffff0000, v26
  v_lshlrev_b32 v70, 16, v27
  v_and_b32 v71, 0xffff0000, v27
  v_lshlrev_b32 v72, 16, v28
  v_and_b32 v73, 0xffff0000, v28
  v_lshlrev_b32 v74, 16, v29
  v_and_b32 v75, 0xffff0000, v29
  v_lshlrev_b32 v76, 16, v30
  v_and_b32 v77, 0xffff0000, v30
  v_lshlrev_b32 v78, 16, v31
  v_and_b32 v79, 0xffff0000, v31
  v_lshlrev_b32 v80, 16, v32
  v_and_b32 v81, 0xffff0000, v32
  v_lshlrev_b32 v82, 16, v33
  v_and_b32 v83, 0xffff0000, v33
  v_lshlrev_b32 v84, 16, v34
  v_and_b32 v85, 0xffff0000, v34
  v_lshlrev_b32 v86, 16, v35
  v_and_b32 v87, 0xffff0000, v35
  v_lshlrev_b32 v88, 16, v36
  v_and_b32 v89, 0xffff0000, v36
  v_lshlrev_b32 v90, 16, v37
  v_and_b32 v91, 0xffff0000, v37
  v_lshlrev_b32 v92, 16, v38
  v_and_b32 v93, 0xffff0000, v38
  v_lshlrev_b32 v94, 16, v39
  v_and_b32 v95, 0xffff0000, v39
  v_lshlrev_b32 v96, 16, v40
  v_and_b32 v97, 0xffff0000, v40
  v_lshlrev_b32 v98, 16, v41
  v_and_b32 v99, 0xffff0000, v41
  v_lshlrev_b32 v100, 16, v42
  v_and_b32 v101, 0xffff0000, v42
  v_lshlrev_b32 v102, 16, v43
  v_and_b32 v103, 0xffff0000, v43
  v_lshlrev_b32 v104, 16, v44
  v_and_b32 v105, 0xffff0000, v44
  v_lshlrev_b32 v106, 16, v45
  v_and_b32 v107, 0xffff0000, v45
  v_lshlrev_b32 v108, 16, v46
  v_and_b32 v109, 0xffff0000, v46
  v_lshlrev_b32 v110, 16, v47
  v_and_b32 v111, 0xffff0000, v47
  v_pk_add_f32 v[12:13], v[48:49], v[50:51]
  v_pk_mul_f32 v[14:15], v[48:49], v[48:49]
  v_pk_fma_f32 v[14:15], v[50:51], v[50:51], v[14:15]
  v_pk_add_f32 v[12:13], v[12:13], v[52:53]
  v_pk_fma_f32 v[14:15], v[52:53], v[52:53], v[14:15]
  v_pk_add_f32 v[12:13], v[12:13], v[54:55]
  v_pk_fma_f32 v[14:15], v[54:55], v[54:55], v[14:15]
  v_pk_add_f32 v[12:13], v[12:13], v[56:57]
  v_pk_fma_f32 v[14:15], v[56:57], v[56:57], v[14:15]
  v_pk_add_f32 v[12:13], v[12:13], v[58:59]
  v_pk_fma_f32 v[14:15], v[58:59], v[58:59], v[14:15]
  v_pk_add_f32 v[12:13], v[12:13], v[60:61]
  v_pk_fma_f32 v[14:15], v[60:61], v[60:61], v[14:15]
  v_pk_add_f32 v[12:13], v[12:13], v[62:63]
  v_pk_fma_f32 v[14:15], v[62:63], v[62:63], v[14:15]
  v_pk_add_f32 v[12:13], v[12:13], v[64:65]
  v_pk_fma_f32 v[14:15], v[64:65], v[64:65], v[14:15]
  v_pk_add_f32 v[12:13], v[12:13], v[66:67]
  v_pk_fma_f32 v[14:15], v[66:67], v[66:67], v[14:15]
  v_pk_add_f32 v[12:13], v[12:13], v[68:69]
  v_pk_fma_f32 v[14:15], v[68:69], v[68:69], v[14:15]
  v_pk_add_f32 v[12:13], v[12:13], v[70:71]
  v_pk_fma_f32 v[14:15], v[70:71], v[70:71], v[14:15]
  v_pk_add_f32 v[12:13], v[12:13], v[72:73]
  v_pk_fma_f32 v[14:15], v[72:73], v[72:73], v[14:15]
  v_pk_add_f32 v[12:13], v[12:13], v[74:75]
  v_pk_fma_f32 v[14:15], v[74:75], v[74:75], v[14:15]
  v_pk_add_f32 v[12:13], v[12:13], v[76:77]
  v_pk_fma_f32 v[14:15], v[76:77], v[76:77], v[14:15]
  v_pk_add_f32 v[12:13], v[12:13], v[78:79]
  v_pk_fma_f32 v[14:15], v[78:79], v[78:79], v[14:15]
  v_pk_add_f32 v[12:13], v[12:13], v[80:81]
  v_pk_fma_f32 v[14:15], v[80:81], v[80:81], v[14:15]
  v_pk_add_f32 v[12:13], v[12:13], v[82:83]
  v_pk_fma_f32 v[14:15], v[82:83], v[82:83], v[14:15]
  v_pk_add_f32 v[12:13], v[12:13], v[84:85]
  v_pk_fma_f32 v[14:15], v[84:85], v[84:85], v[14:15]
  v_pk_add_f32 v[12:13], v[12:13], v[86:87]
  v_pk_fma_f32 v[14:15], v[86:87], v[86:87], v[14:15]
  v_pk_add_f32 v[12:13], v[12:13], v[88:89]
  v_pk_fma_f32 v[14:15], v[88:89], v[88:89], v[14:15]
  v_pk_add_f32 v[12:13], v[12:13], v[90:91]
  v_pk_fma_f32 v[14:15], v[90:91], v[90:91], v[14:15]
  v_pk_add_f32 v[12:13], v[12:13], v[92:93]
  v_pk_fma_f32 v[14:15], v[92:93], v[92:93], v[14:15]
  v_pk_add_f32 v[12:13], v[12:13], v[94:95]
  v_pk_fma_f32 v[14:15], v[94:95], v[94:95], v[14:15]
  v_pk_add_f32 v[12:13], v[12:13], v[96:97]
  v_pk_fma_f32 v[14:15], v[96:97], v[96:97], v[14:15]
  v_pk_add_f32 v[12:13], v[12:13], v[98:99]
  v_pk_fma_f32 v[14:15], v[98:99], v[98:99], v[14:15]
  v_pk_add_f32 v[12:13], v[12:13], v[100:101]
  v_pk_fma_f32 v[14:15], v[100:101], v[100:101], v[14:15]
  v_pk_add_f32 v[12:13], v[12:13], v[102:103]
  v_pk_fma_f32 v[14:15], v[102:103], v[102:103], v[14:15]
  v_pk_add_f32 v[12:13], v[12:13], v[104:105]
  v_pk_fma_f32 v[14:15], v[104:105], v[104:105], v[14:15]
  v_pk_add_f32 v[12:13], v[12:13], v[106:107]
  v_pk_fma_f32 v[14:15], v[106:107], v[106:107], v[14:15]
  v_pk_add_f32 v[12:13], v[12:13], v[108:109]
  v_pk_fma_f32 v[14:15], v[108:109], v[108:109], v[14:15]
  v_pk_add_f32 v[12:13], v[12:13], v[110:111]
  v_pk_fma_f32 v[14:15], v[110:111], v[110:111], v[14:15]
  v_add_f32 v12, v12, v13
  v_add_f32 v14, v14, v15
  s_nop 1
  v_add_f32_dpp v12, v12, v12 quad_perm:[1,0,3,2] row_mask:0xf bank_mask:0xf
  s_nop 1
  v_add_f32_dpp v12, v12, v12 quad_perm:[2,3,0,1] row_mask:0xf bank_mask:0xf
  s_nop 1
  v_add_f32_dpp v12, v12, v12 row_half_mirror row_mask:0xf bank_mask:0xf
  s_nop 1
  v_add_f32_dpp v14, v14, v14 quad_perm:[1,0,3,2] row_mask:0xf bank_mask:0xf
  s_nop 1
  v_add_f32_dpp v14, v14, v14 quad_perm:[2,3,0,1] row_mask:0xf bank_mask:0xf
  s_nop 1
  v_add_f32_dpp v14, v14, v14 row_half_mirror row_mask:0xf bank_mask:0xf
  v_mul_f32 v12, 0x3b000000, v12
  v_mul_f32 v14, 0x3b000000, v14
  v_fma_f32 v14, -v12, v12, v14
  v_max_f32 v14, 0, v14
  v_add_f32 v14, 0x3727c5ac, v14
  v_rsq_f32 v14, v14
  v_bfe_u32 v10, v5, 1, 3
  v_xor_b32 v10, v10, v6
  v_mul_f32 v12, v12, v14
  v_mov_b32 v15, v14
  v_mul_f32 v12, -1.0, v12
  v_lshlrev_b32 v10, 4, v10
  v_mov_b32 v13, v12
  v_lshl_add_u32 v10, v5, 7, v10
  v_pk_fma_f32 v[48:49], v[48:49], v[14:15], v[12:13]
  v_pk_fma_f32 v[50:51], v[50:51], v[14:15], v[12:13]
  v_pk_fma_f32 v[52:53], v[52:53], v[14:15], v[12:13]
  v_pk_fma_f32 v[54:55], v[54:55], v[14:15], v[12:13]
  v_cvt_pk_bf16_f32 v16, v48, v49
  v_cvt_pk_bf16_f32 v17, v50, v51
  v_cvt_pk_bf16_f32 v18, v52, v53
  v_cvt_pk_bf16_f32 v19, v54, v55
  ds_write_b128 v10, v[16:19] offset:0
  v_pk_fma_f32 v[56:57], v[56:57], v[14:15], v[12:13]
  v_pk_fma_f32 v[58:59], v[58:59], v[14:15], v[12:13]
  v_pk_fma_f32 v[60:61], v[60:61], v[14:15], v[12:13]
  v_pk_fma_f32 v[62:63], v[62:63], v[14:15], v[12:13]
  v_cvt_pk_bf16_f32 v20, v56, v57
  v_cvt_pk_bf16_f32 v21, v58, v59
  v_cvt_pk_bf16_f32 v22, v60, v61
  v_cvt_pk_bf16_f32 v23, v62, v63
  ds_write_b128 v10, v[20:23] offset:8192
  v_pk_fma_f32 v[64:65], v[64:65], v[14:15], v[12:13]
  v_pk_fma_f32 v[66:67], v[66:67], v[14:15], v[12:13]
  v_pk_fma_f32 v[68:69], v[68:69], v[14:15], v[12:13]
  v_pk_fma_f32 v[70:71], v[70:71], v[14:15], v[12:13]
  v_cvt_pk_bf16_f32 v24, v64, v65
  v_cvt_pk_bf16_f32 v25, v66, v67
  v_cvt_pk_bf16_f32 v26, v68, v69
  v_cvt_pk_bf16_f32 v27, v70, v71
  ds_write_b128 v10, v[24:27] offset:16384
  v_pk_fma_f32 v[72:73], v[72:73], v[14:15], v[12:13]
  v_pk_fma_f32 v[74:75], v[74:75], v[14:15], v[12:13]
  v_pk_fma_f32 v[76:77], v[76:77], v[14:15], v[12:13]
  v_pk_fma_f32 v[78:79], v[78:79], v[14:15], v[12:13]
  v_cvt_pk_bf16_f32 v28, v72, v73
  v_cvt_pk_bf16_f32 v29, v74, v75
  v_cvt_pk_bf16_f32 v30, v76, v77
  v_cvt_pk_bf16_f32 v31, v78, v79
  ds_write_b128 v10, v[28:31] offset:24576
  v_pk_fma_f32 v[80:81], v[80:81], v[14:15], v[12:13]
  v_pk_fma_f32 v[82:83], v[82:83], v[14:15], v[12:13]
  v_pk_fma_f32 v[84:85], v[84:85], v[14:15], v[12:13]
  v_pk_fma_f32 v[86:87], v[86:87], v[14:15], v[12:13]
  v_cvt_pk_bf16_f32 v32, v80, v81
  v_cvt_pk_bf16_f32 v33, v82, v83
  v_cvt_pk_bf16_f32 v34, v84, v85
  v_cvt_pk_bf16_f32 v35, v86, v87
  ds_write_b128 v10, v[32:35] offset:32768
  v_pk_fma_f32 v[88:89], v[88:89], v[14:15], v[12:13]
  v_pk_fma_f32 v[90:91], v[90:91], v[14:15], v[12:13]
  v_pk_fma_f32 v[92:93], v[92:93], v[14:15], v[12:13]
  v_pk_fma_f32 v[94:95], v[94:95], v[14:15], v[12:13]
  v_cvt_pk_bf16_f32 v36, v88, v89
  v_cvt_pk_bf16_f32 v37, v90, v91
  v_cvt_pk_bf16_f32 v38, v92, v93
  v_cvt_pk_bf16_f32 v39, v94, v95
  ds_write_b128 v10, v[36:39] offset:40960
  v_pk_fma_f32 v[96:97], v[96:97], v[14:15], v[12:13]
  v_pk_fma_f32 v[98:99], v[98:99], v[14:15], v[12:13]
  v_pk_fma_f32 v[100:101], v[100:101], v[14:15], v[12:13]
  v_pk_fma_f32 v[102:103], v[102:103], v[14:15], v[12:13]
  v_cvt_pk_bf16_f32 v40, v96, v97
  v_cvt_pk_bf16_f32 v41, v98, v99
  v_cvt_pk_bf16_f32 v42, v100, v101
  v_cvt_pk_bf16_f32 v43, v102, v103
  ds_write_b128 v10, v[40:43] offset:49152
  v_pk_fma_f32 v[104:105], v[104:105], v[14:15], v[12:13]
  v_pk_fma_f32 v[106:107], v[106:107], v[14:15], v[12:13]
  v_pk_fma_f32 v[108:109], v[108:109], v[14:15], v[12:13]
  v_pk_fma_f32 v[110:111], v[110:111], v[14:15], v[12:13]
  v_cvt_pk_bf16_f32 v44, v104, v105
  v_cvt_pk_bf16_f32 v45, v106, v107
  v_cvt_pk_bf16_f32 v46, v108, v109
  v_cvt_pk_bf16_f32 v47, v110, v111
  ds_write_b128 v10, v[44:47] offset:57344
ka_kernel_noln:
  s_and_b32 s56, s48, 1
  s_lshl_b32 s56, s56, 6
  v_bfe_u32 v5, v2, 2, 2
  v_mad_u32_u24 v11, v4, 8, v5
  v_mul_u32_u24 v11, 128, v11
  v_bfe_u32 v6, v2, 4, 1
  v_lshlrev_b32 v6, 5, v6
  v_and_b32 v5, 3, v2
  v_lshl_add_u32 v6, v5, 3, v6
  v_add_u32 v6, s56, v6
  v_bfe_u32 v5, v2, 3, 1
  v_lshlrev_b32 v5, 6, v5
  v_xor_b32 v6, v5, v6
  v_add_u32 v11, v11, v6
  s_lshr_b32 s56, s48, 1
  s_lshl_b32 s56, s56, 13
  s_add_u32 s56, s56, 65536
  v_add_u32 v11, s56, v11
  v_add_u32 v10, 49152, v11
  s_lshl_b32 s56, s49, 12
  v_lshlrev_b32 v5, 7, v3
  v_add_u32 v5, s56, v5
  v_bfe_u32 v6, v3, 1, 3
  v_xor_b32 v6, v6, v4
  v_xor_b32 v7, 0, v6
  v_lshl_add_u32 v12, v7, 4, v5
  v_xor_b32 v7, 2, v6
  v_lshl_add_u32 v13, v7, 4, v5
  v_xor_b32 v7, 4, v6
  v_lshl_add_u32 v14, v7, 4, v5
  v_xor_b32 v7, 6, v6
  v_lshl_add_u32 v15, v7, 4, v5
  s_waitcnt vmcnt(6) lgkmcnt(0)
  s_barrier
  ds_read_b64_tr_b16 v[16:17], v11 offset:0
  ds_read_b64_tr_b16 v[18:19], v11 offset:512
  ds_read_b128 v[32:35], v12 offset:0
  ds_read_b64_tr_b16 v[20:21], v11 offset:2048
  ds_read_b64_tr_b16 v[22:23], v11 offset:2560
  ds_read_b128 v[36:39], v13 offset:0
  ds_read_b64_tr_b16 v[24:25], v11 offset:4096
  ds_read_b64_tr_b16 v[26:27], v11 offset:4608
  ds_read_b128 v[40:43], v14 offset:0
  ds_read_b64_tr_b16 v[28:29], v11 offset:6144
  ds_read_b64_tr_b16 v[30:31], v11 offset:6656
  ds_read_b128 v[44:47], v15 offset:0
  s_cmp_lt_u32 s7, 8
  s_cbranch_scc1 ka_kernel_d2
  s_add_u32 m0, s54, 49152
  s_mov_b32 s55, 393216
  buffer_load_dwordx4 v8, s[36:39], s55 offen lds
  buffer_load_dwordx4 v9, s[36:39], s55 offen offset:1024 lds
  s_add_u32 m0, s54, 57344
  s_mov_b32 s55, 394240
  buffer_load_dwordx4 v8, s[36:39], s55 offen lds
  buffer_load_dwordx4 v9, s[36:39], s55 offen offset:1024 lds
  s_add_u32 m0, s54, 65536
  s_mov_b32 s55, 395264
  buffer_load_dwordx4 v8, s[36:39], s55 offen lds
  buffer_load_dwordx4 v9, s[36:39], s55 offen offset:1024 lds
  s_add_u32 m0, s54, 73728
  s_mov_b32 s55, 589824
  buffer_load_dwordx4 v8, s[36:39], s55 offen lds
  buffer_load_dwordx4 v9, s[36:39], s55 offen offset:1024 lds
  s_add_u32 m0, s54, 81920
  s_mov_b32 s55, 590848
  buffer_load_dwordx4 v8, s[36:39], s55 offen lds
  buffer_load_dwordx4 v9, s[36:39], s55 offen offset:1024 lds
  s_add_u32 m0, s54, 90112
  s_mov_b32 s55, 591872
  buffer_load_dwordx4 v8, s[36:39], s55 offen lds
  buffer_load_dwordx4 v9, s[36:39], s55 offen offset:1024 lds
ka_kernel_d2:
  s_waitcnt vmcnt(12) lgkmcnt(0)
  s_barrier
  s_cmp_lt_u32 s7, 8
  s_cbranch_scc1 ka_kernel_d3
  s_add_u32 m0, s54, 0
  s_mov_b32 s55, 786432
  buffer_load_dwordx4 v8, s[36:39], s55 offen lds
  buffer_load_dwordx4 v9, s[36:39], s55 offen offset:1024 lds
  s_add_u32 m0, s54, 8192
  s_mov_b32 s55, 787456
  buffer_load_dwordx4 v8, s[36:39], s55 offen lds
  buffer_load_dwordx4 v9, s[36:39], s55 offen offset:1024 lds
  s_add_u32 m0, s54, 16384
  s_mov_b32 s55, 788480
  buffer_load_dwordx4 v8, s[36:39], s55 offen lds
  buffer_load_dwordx4 v9, s[36:39], s55 offen offset:1024 lds
ka_kernel_d3:
  v_mfma_f32_32x32x16_bf16 v[112:127], v[16:19], v[32:35], 0
  ds_read_b64_tr_b16 v[48:49], v11 offset:24576
  ds_read_b64_tr_b16 v[50:51], v11 offset:25088
  ds_read_b128 v[64:67], v12 offset:8192
  v_mfma_f32_32x32x16_bf16 v[112:127], v[20:23], v[36:39], v[112:127]
  ds_read_b64_tr_b16 v[52:53], v11 offset:26624
  ds_read_b64_tr_b16 v[54:55], v11 offset:27136
  ds_read_b128 v[68:71], v13 offset:8192
  v_mfma_f32_32x32x16_bf16 v[112:127], v[24:27], v[40:43], v[112:127]
  ds_read_b64_tr_b16 v[56:57], v11 offset:28672
  ds_read_b64_tr_b16 v[58:59], v11 offset:29184
  ds_read_b128 v[72:75], v14 offset:8192
  v_mfma_f32_32x32x16_bf16 v[112:127], v[28:31], v[44:47], v[112:127]
  ds_read_b64_tr_b16 v[60:61], v11 offset:30720
  ds_read_b64_tr_b16 v[62:63], v11 offset:31232
  ds_read_b128 v[76:79], v15 offset:8192
  s_waitcnt vmcnt(12) lgkmcnt(0)
  s_barrier
  s_cmp_lt_u32 s7, 8
  s_cbranch_scc1 ka_kernel_d4
  s_add_u32 m0, s54, 24576
  s_mov_b32 s55, 983040
  buffer_load_dwordx4 v8, s[36:39], s55 offen lds
  buffer_load_dwordx4 v9, s[36:39], s55 offen offset:1024 lds
  s_add_u32 m0, s54, 32768
  s_mov_b32 s55, 984064
  buffer_load_dwordx4 v8, s[36:39], s55 offen lds
  buffer_load_dwordx4 v9, s[36:39], s55 offen offset:1024 lds
  s_add_u32 m0, s54, 40960
  s_mov_b32 s55, 985088
  buffer_load_dwordx4 v8, s[36:39], s55 offen lds
  buffer_load_dwordx4 v9, s[36:39], s55 offen offset:1024 lds
ka_kernel_d4:
  v_mfma_f32_32x32x16_bf16 v[112:127], v[48:51], v[64:67], v[112:127]
  ds_read_b64_tr_b16 v[16:17], v10 offset:0
  ds_read_b64_tr_b16 v[18:19], v10 offset:512
  ds_read_b128 v[32:35], v12 offset:16384
  v_mfma_f32_32x32x16_bf16 v[112:127], v[52:55], v[68:71], v[112:127]
  ds_read_b64_tr_b16 v[20:21], v10 offset:2048
  ds_read_b64_tr_b16 v[22:23], v10 offset:2560
  ds_read_b128 v[36:39], v13 offset:16384
  v_mfma_f32_32x32x16_bf16 v[112:127], v[56:59], v[72:75], v[112:127]
  ds_read_b64_tr_b16 v[24:25], v10 offset:4096
  ds_read_b64_tr_b16 v[26:27], v10 offset:4608
  ds_read_b128 v[40:43], v14 offset:16384
  v_mfma_f32_32x32x16_bf16 v[112:127], v[60:63], v[76:79], v[112:127]
  ds_read_b64_tr_b16 v[28:29], v10 offset:6144
  ds_read_b64_tr_b16 v[30:31], v10 offset:6656
  ds_read_b128 v[44:47], v15 offset:16384
  s_waitcnt vmcnt(12) lgkmcnt(0)
  s_barrier
  s_cmp_lt_u32 s7, 8
  s_cbranch_scc1 ka_kernel_d5
  s_add_u32 m0, s54, 49152
  s_mov_b32 s55, 1179648
  buffer_load_dwordx4 v8, s[36:39], s55 offen lds
  buffer_load_dwordx4 v9, s[36:39], s55 offen offset:1024 lds
  s_add_u32 m0, s54, 57344
  s_mov_b32 s55, 1180672
  buffer_load_dwordx4 v8, s[36:39], s55 offen lds
  buffer_load_dwordx4 v9, s[36:39], s55 offen offset:1024 lds
  s_add_u32 m0, s54, 65536
  s_mov_b32 s55, 1181696
  buffer_load_dwordx4 v8, s[36:39], s55 offen lds
  buffer_load_dwordx4 v9, s[36:39], s55 offen offset:1024 lds
ka_kernel_d5:
  v_mfma_f32_32x32x16_bf16 v[112:127], v[16:19], v[32:35], v[112:127]
  ds_read_b64_tr_b16 v[48:49], v10 offset:24576
  ds_read_b64_tr_b16 v[50:51], v10 offset:25088
  ds_read_b128 v[64:67], v12 offset:24576
  v_mfma_f32_32x32x16_bf16 v[112:127], v[20:23], v[36:39], v[112:127]
  ds_read_b64_tr_b16 v[52:53], v10 offset:26624
  ds_read_b64_tr_b16 v[54:55], v10 offset:27136
  ds_read_b128 v[68:71], v13 offset:24576
  v_mfma_f32_32x32x16_bf16 v[112:127], v[24:27], v[40:43], v[112:127]
  ds_read_b64_tr_b16 v[56:57], v10 offset:28672
  ds_read_b64_tr_b16 v[58:59], v10 offset:29184
  ds_read_b128 v[72:75], v14 offset:24576
  v_mfma_f32_32x32x16_bf16 v[112:127], v[28:31], v[44:47], v[112:127]
  ds_read_b64_tr_b16 v[60:61], v10 offset:30720
  ds_read_b64_tr_b16 v[62:63], v10 offset:31232
  ds_read_b128 v[76:79], v15 offset:24576
  s_waitcnt vmcnt(12) lgkmcnt(0)
  s_barrier
  s_cmp_lt_u32 s7, 8
  s_cbranch_scc1 ka_kernel_d6
  s_add_u32 m0, s54, 73728
  s_mov_b32 s55, 1376256
  buffer_load_dwordx4 v8, s[36:39], s55 offen lds
  buffer_load_dwordx4 v9, s[36:39], s55 offen offset:1024 lds
  s_add_u32 m0, s54, 81920
  s_mov_b32 s55, 1377280
  buffer_load_dwordx4 v8, s[36:39], s55 offen lds
  buffer_load_dwordx4 v9, s[36:39], s55 offen offset:1024 lds
  s_add_u32 m0, s54, 90112
  s_mov_b32 s55, 1378304
  buffer_load_dwordx4 v8, s[36:39], s55 offen lds
  buffer_load_dwordx4 v9, s[36:39], s55 offen offset:1024 lds
ka_kernel_d6:
  v_mfma_f32_32x32x16_bf16 v[112:127], v[48:51], v[64:67], v[112:127]
  ds_read_b64_tr_b16 v[16:17], v11 offset:0
  ds_read_b64_tr_b16 v[18:19], v11 offset:512
  ds_read_b128 v[32:35], v12 offset:32768
  v_mfma_f32_32x32x16_bf16 v[112:127], v[52:55], v[68:71], v[112:127]
  ds_read_b64_tr_b16 v[20:21], v11 offset:2048
  ds_read_b64_tr_b16 v[22:23], v11 offset:2560
  ds_read_b128 v[36:39], v13 offset:32768
  v_mfma_f32_32x32x16_bf16 v[112:127], v[56:59], v[72:75], v[112:127]
  ds_read_b64_tr_b16 v[24:25], v11 offset:4096
  ds_read_b64_tr_b16 v[26:27], v11 offset:4608
  ds_read_b128 v[40:43], v14 offset:32768
  v_mfma_f32_32x32x16_bf16 v[112:127], v[60:63], v[76:79], v[112:127]
  ds_read_b64_tr_b16 v[28:29], v11 offset:6144
  ds_read_b64_tr_b16 v[30:31], v11 offset:6656
  ds_read_b128 v[44:47], v15 offset:32768
  s_waitcnt vmcnt(12) lgkmcnt(0)
  s_barrier
  v_mfma_f32_32x32x16_bf16 v[112:127], v[16:19], v[32:35], v[112:127]
  ds_read_b64_tr_b16 v[48:49], v11 offset:24576
  ds_read_b64_tr_b16 v[50:51], v11 offset:25088
  ds_read_b128 v[64:67], v12 offset:40960
  v_mfma_f32_32x32x16_bf16 v[112:127], v[20:23], v[36:39], v[112:127]
  ds_read_b64_tr_b16 v[52:53], v11 offset:26624
  ds_read_b64_tr_b16 v[54:55], v11 offset:27136
  ds_read_b128 v[68:71], v13 offset:40960
  v_mfma_f32_32x32x16_bf16 v[112:127], v[24:27], v[40:43], v[112:127]
  ds_read_b64_tr_b16 v[56:57], v11 offset:28672
  ds_read_b64_tr_b16 v[58:59], v11 offset:29184
  ds_read_b128 v[72:75], v14 offset:40960
  v_mfma_f32_32x32x16_bf16 v[112:127], v[28:31], v[44:47], v[112:127]
  ds_read_b64_tr_b16 v[60:61], v11 offset:30720
  ds_read_b64_tr_b16 v[62:63], v11 offset:31232
  ds_read_b128 v[76:79], v15 offset:40960
  s_cmp_lg_u32 s7, 8
  s_cbranch_scc1 ka_kernel_wp
  s_mov_b32 m0, 65536
  s_lshl_b32 s56, s6, 11
  v_lshlrev_b32 v5, 4, v2
  buffer_load_dwordx4 v5, s[44:47], s56 offen lds
  buffer_load_dwordx4 v5, s[44:47], s56 offen offset:1024 lds
ka_kernel_wp:
  s_waitcnt vmcnt(6) lgkmcnt(0)
  s_barrier
  v_mfma_f32_32x32x16_bf16 v[112:127], v[48:51], v[64:67], v[112:127]
  ds_read_b64_tr_b16 v[16:17], v10 offset:0
  ds_read_b64_tr_b16 v[18:19], v10 offset:512
  ds_read_b128 v[32:35], v12 offset:49152
  v_mfma_f32_32x32x16_bf16 v[112:127], v[52:55], v[68:71], v[112:127]
  ds_read_b64_tr_b16 v[20:21], v10 offset:2048
  ds_read_b64_tr_b16 v[22:23], v10 offset:2560
  ds_read_b128 v[36:39], v13 offset:49152
  v_mfma_f32_32x32x16_bf16 v[112:127], v[56:59], v[72:75], v[112:127]
  ds_read_b64_tr_b16 v[24:25], v10 offset:4096
  ds_read_b64_tr_b16 v[26:27], v10 offset:4608
  ds_read_b128 v[40:43], v14 offset:49152
  v_mfma_f32_32x32x16_bf16 v[112:127], v[60:63], v[76:79], v[112:127]
  ds_read_b64_tr_b16 v[28:29], v10 offset:6144
  ds_read_b64_tr_b16 v[30:31], v10 offset:6656
  ds_read_b128 v[44:47], v15 offset:49152
  s_waitcnt vmcnt(0) lgkmcnt(0)
  s_barrier
  v_mfma_f32_32x32x16_bf16 v[112:127], v[16:19], v[32:35], v[112:127]
  ds_read_b64_tr_b16 v[48:49], v10 offset:24576
  ds_read_b64_tr_b16 v[50:51], v10 offset:25088
  ds_read_b128 v[64:67], v12 offset:57344
  v_mfma_f32_32x32x16_bf16 v[112:127], v[20:23], v[36:39], v[112:127]
  ds_read_b64_tr_b16 v[52:53], v10 offset:26624
  ds_read_b64_tr_b16 v[54:55], v10 offset:27136
  ds_read_b128 v[68:71], v13 offset:57344
  v_mfma_f32_32x32x16_bf16 v[112:127], v[24:27], v[40:43], v[112:127]
  ds_read_b64_tr_b16 v[56:57], v10 offset:28672
  ds_read_b64_tr_b16 v[58:59], v10 offset:29184
  ds_read_b128 v[72:75], v14 offset:57344
  v_mfma_f32_32x32x16_bf16 v[112:127], v[28:31], v[44:47], v[112:127]
  ds_read_b64_tr_b16 v[60:61], v10 offset:30720
  ds_read_b64_tr_b16 v[62:63], v10 offset:31232
  ds_read_b128 v[76:79], v15 offset:57344
  s_waitcnt lgkmcnt(9)
  v_mfma_f32_32x32x16_bf16 v[112:127], v[48:51], v[64:67], v[112:127]
  s_waitcnt lgkmcnt(6)
  v_mfma_f32_32x32x16_bf16 v[112:127], v[52:55], v[68:71], v[112:127]
  s_waitcnt lgkmcnt(3)
  v_mfma_f32_32x32x16_bf16 v[112:127], v[56:59], v[72:75], v[112:127]
  s_waitcnt lgkmcnt(0)
  v_mfma_f32_32x32x16_bf16 v[112:127], v[60:63], v[76:79], v[112:127]
  s_mov_b32 s60, 1069066811
  s_mov_b32 s61, 1069066811
  s_mov_b32 s62, 3216550459
  v_bfe_u32 v5, v2, 4, 1
  v_mul_u32_u24 v5, 0x8000, v5
  v_lshl_or_b32 v5, v5, 16, v5
  v_bfe_u32 v6, v2, 2, 2
  v_lshl_add_u32 v6, v4, 2, v6
  v_lshlrev_b32 v6, 5, v6
  v_and_b32 v7, 3, v2
  v_lshl_add_u32 v6, v7, 3, v6
  s_and_b32 s56, s48, 1
  s_lshl_b32 s56, s56, 10
  s_add_u32 s56, s56, 65536
  v_add_u32 v6, s56, v6
  ds_read_b64_tr_b16 v[128:129], v6 offset:0
  ds_read_b64_tr_b16 v[130:131], v6 offset:256
  ds_read_b64_tr_b16 v[132:133], v6 offset:512
  ds_read_b64_tr_b16 v[134:135], v6 offset:768
  s_waitcnt lgkmcnt(0)
  v_xor_b32 v128, v5, v128
  v_xor_b32 v129, v5, v129
  v_xor_b32 v130, v5, v130
  v_xor_b32 v131, v5, v131
  v_xor_b32 v132, v5, v132
  v_xor_b32 v133, v5, v133
  v_xor_b32 v134, v5, v134
  v_xor_b32 v135, v5, v135
  v_cvt_pk_bf16_f32 v16, v112, v113
  v_cvt_pk_bf16_f32 v17, v114, v115
  v_cvt_pk_bf16_f32 v18, v116, v117
  v_cvt_pk_bf16_f32 v19, v118, v119
  v_cvt_pk_bf16_f32 v20, v120, v121
  v_cvt_pk_bf16_f32 v21, v122, v123
  v_cvt_pk_bf16_f32 v22, v124, v125
  v_cvt_pk_bf16_f32 v23, v126, v127
  s_lshl_b32 s56, s49, 5
  v_add_u32 v6, s56, v3
  s_and_b32 s57, s48, 1
  s_cmp_ge_u32 s48, 4
  s_cbranch_scc1 ka_kernel_v
  s_cmp_ge_u32 s48, 2
  s_cbranch_scc1 ka_kernel_sm
  s_barrier
  s_mov_b32 s44, s14
  s_mov_b32 s45, s15
  s_mov_b32 s46, 524288
  s_mov_b32 s47, 0x00020000
  s_sub_u32 s68, s7, 0
  s_cmp_ge_u32 s68, 2
  s_cbranch_scc1 pf2
  s_lshl_b32 s68, s68, 12
  v_lshlrev_b32 v140, 6, v2
  v_add_u32 v140, s68, v140
  s_lshr_b32 s69, s2, 3
  s_mul_i32 s69, s69, 16384
  buffer_load_dword v141, v140, s[44:47], s69 offen
  s_add_u32 s69, s69, 8192
  buffer_load_dword v142, v140, s[44:47], s69 offen
pf2:
  s_mov_b32 s44, s18
  s_mov_b32 s45, s19
  s_mov_b32 s46, 1409024
  s_mov_b32 s47, 0x00020000
  s_sub_u32 s68, s7, 6
  s_cmp_ge_u32 s68, 2
  s_cbranch_scc1 pf3
  s_lshl_b32 s68, s68, 12
  v_lshlrev_b32 v140, 6, v2
  v_add_u32 v140, s68, v140
  s_mul_i32 s69, s2, 5504
  buffer_load_dword v141, v140, s[44:47], s69 offen
pf3:
  s_mov_b32 s44, s24
  s_mov_b32 s45, s25
  s_mov_b32 s46, 704512
  s_mov_b32 s47, 0x00020000
  s_sub_u32 s68, s7, 7
  s_cmp_ge_u32 s68, 1
  s_cbranch_scc1 pf4
  s_lshl_b32 s68, s68, 12
  v_lshlrev_b32 v142, 6, v2
  v_add_u32 v142, s68, v142
  s_mul_i32 s69, s2, 2752
  buffer_load_dword v143, v142, s[44:47], s69 offen
pf4:
ka_kernel_sm:
  v_mfma_f32_32x32x16_bf16 v[32:47], v[128:131], v[16:19], 0
  v_mfma_f32_32x32x16_bf16 v[48:63], v[132:135], v[20:23], 0
  s_nop 7
  s_nop 3
  v_max3_f32 v24, v32, v33, v34
  v_max3_f32 v24, v24, v35, v36
  v_max3_f32 v24, v24, v37, v38
  v_max_f32 v24, v24, v39
  v_mov_b32 v25, v24
  s_nop 1
  v_permlane32_swap_b32 v24, v25
  s_nop 1
  v_max_f32 v24, v24, v25
  v_mul_f32 v24, s62, v24
  v_mov_b32 v25, v24
  v_pk_fma_f32 v[32:33], v[32:33], s[60:61], v[24:25]
  v_pk_fma_f32 v[34:35], v[34:35], s[60:61], v[24:25]
  v_pk_fma_f32 v[36:37], v[36:37], s[60:61], v[24:25]
  v_pk_fma_f32 v[38:39], v[38:39], s[60:61], v[24:25]
  v_exp_f32 v32, v32
  v_exp_f32 v33, v33
  v_exp_f32 v34, v34
  v_exp_f32 v35, v35
  v_exp_f32 v36, v36
  v_exp_f32 v37, v37
  v_exp_f32 v38, v38
  v_exp_f32 v39, v39
  v_pk_add_f32 v[24:25], v[32:33], v[34:35]
  v_pk_add_f32 v[24:25], v[24:25], v[36:37]
  v_pk_add_f32 v[24:25], v[24:25], v[38:39]
  v_add_f32 v24, v24, v25
  v_mov_b32 v25, v24
  s_nop 1
  v_permlane32_swap_b32 v24, v25
  s_nop 1
  v_add_f32 v24, v24, v25
  v_rcp_f32 v24, v24
  s_nop 0
  v_mov_b32 v25, v24
  v_pk_mul_f32 v[32:33], v[32:33], v[24:25]
  v_pk_mul_f32 v[34:35], v[34:35], v[24:25]
  v_pk_mul_f32 v[36:37], v[36:37], v[24:25]
  v_pk_mul_f32 v[38:39], v[38:39], v[24:25]
  v_max3_f32 v26, v40, v41, v42
  v_max3_f32 v26, v26, v43, v44
  v_max3_f32 v26, v26, v45, v46
  v_max_f32 v26, v26, v47
  v_mov_b32 v27, v26
  s_nop 1
  v_permlane32_swap_b32 v26, v27
  s_nop 1
  v_max_f32 v26, v26, v27
  v_mul_f32 v26, s62, v26
  v_mov_b32 v27, v26
  v_pk_fma_f32 v[40:41], v[40:41], s[60:61], v[26:27]
  v_pk_fma_f32 v[42:43], v[42:43], s[60:61], v[26:27]
  v_pk_fma_f32 v[44:45], v[44:45], s[60:61], v[26:27]
  v_pk_fma_f32 v[46:47], v[46:47], s[60:61], v[26:27]
  v_exp_f32 v40, v40
  v_exp_f32 v41, v41
  v_exp_f32 v42, v42
  v_exp_f32 v43, v43
  v_exp_f32 v44, v44
  v_exp_f32 v45, v45
  v_exp_f32 v46, v46
  v_exp_f32 v47, v47
  v_pk_add_f32 v[26:27], v[40:41], v[42:43]
  v_pk_add_f32 v[26:27], v[26:27], v[44:45]
  v_pk_add_f32 v[26:27], v[26:27], v[46:47]
  v_add_f32 v26, v26, v27
  v_mov_b32 v27, v26
  s_nop 1
  v_permlane32_swap_b32 v26, v27
  s_nop 1
  v_add_f32 v26, v26, v27
  v_rcp_f32 v26, v26
  s_nop 0
  v_mov_b32 v27, v26
  v_pk_mul_f32 v[40:41], v[40:41], v[26:27]
  v_pk_mul_f32 v[42:43], v[42:43], v[26:27]
  v_pk_mul_f32 v[44:45], v[44:45], v[26:27]
  v_pk_mul_f32 v[46:47], v[46:47], v[26:27]
  v_max3_f32 v24, v48, v49, v50
  v_max3_f32 v24, v24, v51, v52
  v_max3_f32 v24, v24, v53, v54
  v_max_f32 v24, v24, v55
  v_mov_b32 v25, v24
  s_nop 1
  v_permlane32_swap_b32 v24, v25
  s_nop 1
  v_max_f32 v24, v24, v25
  v_mul_f32 v24, s62, v24
  v_mov_b32 v25, v24
  v_pk_fma_f32 v[48:49], v[48:49], s[60:61], v[24:25]
  v_pk_fma_f32 v[50:51], v[50:51], s[60:61], v[24:25]
  v_pk_fma_f32 v[52:53], v[52:53], s[60:61], v[24:25]
  v_pk_fma_f32 v[54:55], v[54:55], s[60:61], v[24:25]
  v_exp_f32 v48, v48
  v_exp_f32 v49, v49
  v_exp_f32 v50, v50
  v_exp_f32 v51, v51
  v_exp_f32 v52, v52
  v_exp_f32 v53, v53
  v_exp_f32 v54, v54
  v_exp_f32 v55, v55
  v_pk_add_f32 v[24:25], v[48:49], v[50:51]
  v_pk_add_f32 v[24:25], v[24:25], v[52:53]
  v_pk_add_f32 v[24:25], v[24:25], v[54:55]
  v_add_f32 v24, v24, v25
  v_mov_b32 v25, v24
  s_nop 1
  v_permlane32_swap_b32 v24, v25
  s_nop 1
  v_add_f32 v24, v24, v25
  v_rcp_f32 v24, v24
  s_nop 0
  v_mov_b32 v25, v24
  v_pk_mul_f32 v[48:49], v[48:49], v[24:25]
  v_pk_mul_f32 v[50:51], v[50:51], v[24:25]
  v_pk_mul_f32 v[52:53], v[52:53], v[24:25]
  v_pk_mul_f32 v[54:55], v[54:55], v[24:25]
  v_max3_f32 v26, v56, v57, v58
  v_max3_f32 v26, v26, v59, v60
  v_max3_f32 v26, v26, v61, v62
  v_max_f32 v26, v26, v63
  v_mov_b32 v27, v26
  s_nop 1
  v_permlane32_swap_b32 v26, v27
  s_nop 1
  v_max_f32 v26, v26, v27
  v_mul_f32 v26, s62, v26
  v_mov_b32 v27, v26
  v_pk_fma_f32 v[56:57], v[56:57], s[60:61], v[26:27]
  v_pk_fma_f32 v[58:59], v[58:59], s[60:61], v[26:27]
  v_pk_fma_f32 v[60:61], v[60:61], s[60:61], v[26:27]
  v_pk_fma_f32 v[62:63], v[62:63], s[60:61], v[26:27]
  v_exp_f32 v56, v56
  v_exp_f32 v57, v57
  v_exp_f32 v58, v58
  v_exp_f32 v59, v59
  v_exp_f32 v60, v60
  v_exp_f32 v61, v61
  v_exp_f32 v62, v62
  v_exp_f32 v63, v63
  v_pk_add_f32 v[26:27], v[56:57], v[58:59]
  v_pk_add_f32 v[26:27], v[26:27], v[60:61]
  v_pk_add_f32 v[26:27], v[26:27], v[62:63]
  v_add_f32 v26, v26, v27
  v_mov_b32 v27, v26
  s_nop 1
  v_permlane32_swap_b32 v26, v27
  s_nop 1
  v_add_f32 v26, v26, v27
  v_rcp_f32 v26, v26
  s_nop 0
  v_mov_b32 v27, v26
  v_pk_mul_f32 v[56:57], v[56:57], v[26:27]
  v_pk_mul_f32 v[58:59], v[58:59], v[26:27]
  v_pk_mul_f32 v[60:61], v[60:61], v[26:27]
  v_pk_mul_f32 v[62:63], v[62:63], v[26:27]
  v_cvt_pk_bf16_f32 v64, v32, v33
  v_cvt_pk_bf16_f32 v65, v34, v35
  v_cvt_pk_bf16_f32 v66, v36, v37
  v_cvt_pk_bf16_f32 v67, v38, v39
  v_cvt_pk_bf16_f32 v68, v40, v41
  v_cvt_pk_bf16_f32 v69, v42, v43
  v_cvt_pk_bf16_f32 v70, v44, v45
  v_cvt_pk_bf16_f32 v71, v46, v47
  v_cvt_pk_bf16_f32 v72, v48, v49
  v_cvt_pk_bf16_f32 v73, v50, v51
  v_cvt_pk_bf16_f32 v74, v52, v53
  v_cvt_pk_bf16_f32 v75, v54, v55
  v_cvt_pk_bf16_f32 v76, v56, v57
  v_cvt_pk_bf16_f32 v77, v58, v59
  v_cvt_pk_bf16_f32 v78, v60, v61
  v_cvt_pk_bf16_f32 v79, v62, v63
  s_cmp_ge_u32 s48, 2
  s_cbranch_scc1 ka_kernel_k
  s_lshl_b32 s56, s5, 1
  s_add_u32 s56, s56, s49
  s_lshl_b32 s56, s56, 16
  s_lshl_b32 s58, s6, 13
  s_add_u32 s56, s56, s58
  s_lshl_b32 s58, s57, 12
  s_add_u32 s56, s56, s58
  s_add_u32 s56, s56, 1048576
  v_lshlrev_b32 v7, 4, v2
  buffer_store_dwordx4 v[64:67], v7, s[40:43], s56 offen offset:0
  buffer_store_dwordx4 v[68:71], v7, s[40:43], s56 offen offset:1024
  buffer_store_dwordx4 v[72:75], v7, s[40:43], s56 offen offset:2048
  buffer_store_dwordx4 v[76:79], v7, s[40:43], s56 offen offset:3072
  s_endpgm
ka_kernel_k:
  v_mul_u32_u24 v7, 272, v6
  v_lshl_add_u32 v7, v4, 5, v7
  s_lshl_b32 s56, s57, 7
  v_add_u32 v7, s56, v7
  ds_write_b128 v7, v[64:67] offset:0
  ds_write_b128 v7, v[68:71] offset:16
  ds_write_b128 v7, v[72:75] offset:64
  ds_write_b128 v7, v[76:79] offset:80
  s_waitcnt lgkmcnt(0)
  s_barrier
  s_endpgm
ka_kernel_v:
  v_mul_u32_u24 v7, 144, v6
  v_lshl_add_u32 v7, v4, 4, v7
  s_lshl_b32 s56, s57, 6
  v_add_u32 v7, s56, v7
  ds_write_b128 v7, v[16:19] offset:17408
  ds_write_b128 v7, v[20:23] offset:17440
  s_lshl_b32 s58, s49, 1
  s_add_u32 s58, s58, s57
  s_lshl_b32 s56, s6, 2
  v_mov_b32 v9, 0
  s_mov_b32 s59, 0
ka_kernel_poll:
  buffer_load_dword v8, v9, s[64:67], s56 offen sc0 sc1
  s_add_u32 s59, s59, 1
  s_waitcnt vmcnt(0)
  v_readfirstlane_b32 s63, v8
  s_cmp_gt_u32 s59, 0x4000
  s_cbranch_scc1 ka_kernel_go
  s_cmp_lt_u32 s63, 4
  s_cbranch_scc1 ka_kernel_poll
ka_kernel_go:
  v_bfe_u32 v5, v2, 2, 2
  v_mad_u32_u24 v10, v4, 8, v5
  v_mul_u32_u24 v10, 272, v10
  v_bfe_u32 v6, v2, 4, 1
  v_lshlrev_b32 v6, 5, v6
  v_and_b32 v5, 3, v2
  v_lshl_add_u32 v6, v5, 3, v6
  v_add_u32 v10, v10, v6
  v_bfe_u32 v5, v2, 2, 2
  v_lshl_add_u32 v11, v4, 3, v5
  v_mul_u32_u24 v11, 144, v11
  v_and_b32 v5, 3, v2
  v_lshl_add_u32 v11, v5, 3, v11
  s_lshl_b32 s57, s58, 6
  v_add_u32 v10, s57, v10
  s_lshl_b32 s57, s58, 5
  v_add_u32 v11, s57, v11
  v_cmp_lt_u32 vcc, 15, v3
  v_mov_b32 v12, 0x3f803f80
  s_waitcnt lgkmcnt(0)
  s_barrier
  ds_read_b64_tr_b16 v[16:17], v11 offset:17408
  ds_read_b64_tr_b16 v[32:33], v10 offset:0
  ds_read_b64_tr_b16 v[18:19], v11 offset:17984
  ds_read_b64_tr_b16 v[34:35], v10 offset:1088
  ds_read_b64_tr_b16 v[20:21], v11 offset:19712
  ds_read_b64_tr_b16 v[36:37], v10 offset:4352
  ds_read_b64_tr_b16 v[22:23], v11 offset:20288
  ds_read_b64_tr_b16 v[38:39], v10 offset:5440
  ds_read_b64_tr_b16 v[24:25], v11 offset:22016
  ds_read_b64_tr_b16 v[40:41], v10 offset:8704
  ds_read_b64_tr_b16 v[26:27], v11 offset:22592
  ds_read_b64_tr_b16 v[42:43], v10 offset:9792
  ds_read_b64_tr_b16 v[28:29], v11 offset:24320
  ds_read_b64_tr_b16 v[44:45], v10 offset:13056
  ds_read_b64_tr_b16 v[30:31], v11 offset:24896
  ds_read_b64_tr_b16 v[46:47], v10 offset:14144
  s_waitcnt lgkmcnt(0)
  v_cndmask_b32 v16, v16, v12, vcc
  v_cndmask_b32 v17, v17, v12, vcc
  v_cndmask_b32 v18, v18, v12, vcc
  v_cndmask_b32 v19, v19, v12, vcc
  v_cndmask_b32 v20, v20, v12, vcc
  v_cndmask_b32 v21, v21, v12, vcc
  v_cndmask_b32 v22, v22, v12, vcc
  v_cndmask_b32 v23, v23, v12, vcc
  v_cndmask_b32 v24, v24, v12, vcc
  v_cndmask_b32 v25, v25, v12, vcc
  v_cndmask_b32 v26, v26, v12, vcc
  v_cndmask_b32 v27, v27, v12, vcc
  v_cndmask_b32 v28, v28, v12, vcc
  v_cndmask_b32 v29, v29, v12, vcc
  v_cndmask_b32 v30, v30, v12, vcc
  v_cndmask_b32 v31, v31, v12, vcc
  s_nop 1
  v_mfma_f32_32x32x16_bf16 v[48:63], v[16:19], v[32:35], 0
  v_mfma_f32_32x32x16_bf16 v[48:63], v[20:23], v[36:39], v[48:63]
  v_mfma_f32_32x32x16_bf16 v[48:63], v[24:27], v[40:43], v[48:63]
  v_mfma_f32_32x32x16_bf16 v[48:63], v[28:31], v[44:47], v[48:63]
  s_add_u32 s56, s56, s58
  s_mul_i32 s56, s56, 2176
  v_lshlrev_b32 v7, 2, v3
  v_lshl_add_u32 v7, v4, 9, v7
  s_nop 7
  s_nop 3
  buffer_atomic_add_f32 v48, v7, s[40:43], s56 offen offset:0 sc1
  buffer_atomic_add_f32 v49, v7, s[40:43], s56 offen offset:128 sc1
  buffer_atomic_add_f32 v50, v7, s[40:43], s56 offen offset:256 sc1
  buffer_atomic_add_f32 v51, v7, s[40:43], s56 offen offset:384 sc1
  buffer_atomic_add_f32 v52, v7, s[40:43], s56 offen offset:1024 sc1
  buffer_atomic_add_f32 v53, v7, s[40:43], s56 offen offset:1152 sc1
  buffer_atomic_add_f32 v54, v7, s[40:43], s56 offen offset:1280 sc1
  buffer_atomic_add_f32 v55, v7, s[40:43], s56 offen offset:1408 sc1
  s_mov_b64 exec, 0xffffffff
  buffer_atomic_add_f32 v56, v7, s[40:43], s56 offen offset:2048 sc1
ka_kernel_end:
  s_endpgm
.globl kb1_kernel
.p2align 8
.type kb1_kernel,@function
kb1_kernel:
  s_cmp_ge_u32 s2, 256
  s_cbranch_scc1 kb1_kernel_end
  s_load_dwordx16 s[8:23], s[0:1], 0
  s_load_dwordx8 s[24:31], s[0:1], 64
  s_and_b32 s3, s2, 7
  s_lshr_b32 s4, s2, 3
  s_lshl_b32 s5, s3, 2
  s_lshr_b32 s6, s4, 3
  s_add_u32 s5, s5, s6
  s_and_b32 s6, s4, 7
  v_lshrrev_b32 v1, 6, v0
  v_and_b32 v2, 63, v0
  v_readfirstlane_b32 s7, v1
  v_and_b32 v3, 31, v0
  v_bfe_u32 v4, v0, 5, 1
  s_waitcnt lgkmcnt(0)
  s_mov_b32 s32, s8
  s_mov_b32 s33, s9
  s_mov_b32 s34, 2097152
  s_mov_b32 s35, 0x00020000
  s_mov_b32 s36, s14
  s_mov_b32 s37, s15
  s_mov_b32 s38, 524288
  s_mov_b32 s39, 0x00020000
  s_mov_b32 s40, s30
  s_mov_b32 s41, s31
  s_mov_b32 s42, 268435456
  s_mov_b32 s43, 0x00020000
  s_and_b32 s49, s7, 1
  s_lshr_b32 s48, s7, 1
  v_lshrrev_b32 v5, 3, v2
  v_and_b32 v6, 7, v2
  v_xor_b32 v6, v5, v6
  v_lshlrev_b32 v5, 7, v5
  v_lshl_add_u32 v5, v6, 4, v5
  s_lshl_b32 s56, s7, 2
  s_add_u32 s56, s56, 135168
  v_mov_b32 v162, s56
  v_mov_b32 v163, 0
  ds_write_b32 v162, v163
  s_mul_i32 s56, s48, 17408
  s_lshl_b32 s57, s49, 13
  s_add_u32 s56, s56, s57
  s_add_u32 m0, s56, 65536
  s_waitcnt lgkmcnt(0)
  s_barrier
  s_lshl_b32 s57, s5, 1
  s_add_u32 s57, s57, s49
  s_lshl_b32 s57, s57, 16
  s_lshl_b32 s58, s48, 14
  s_add_u32 s57, s57, s58
  s_add_u32 s57, s57, 1048576
  v_lshlrev_b32 v6, 4, v2
  buffer_load_dwordx4 v5, s[40:43], s56 offen offset:0 lds
  buffer_load_dwordx4 v5, s[40:43], s56 offen offset:1024 lds
  buffer_load_dwordx4 v5, s[40:43], s56 offen offset:2048 lds
  buffer_load_dwordx4 v5, s[40:43], s56 offen offset:3072 lds
  s_add_u32 m0, s56, 69632
  s_add_u32 s56, s56, 4096
  buffer_load_dwordx4 v5, s[40:43], s56 offen offset:0 lds
  buffer_load_dwordx4 v5, s[40:43], s56 offen offset:1024 lds
  buffer_load_dwordx4 v5, s[40:43], s56 offen offset:2048 lds
  buffer_load_dwordx4 v5, s[40:43], s56 offen offset:3072 lds
  s_add_u32 m0, s56, 69632
  s_add_u32 s56, s56, 4096
  s_nop 0
  buffer_load_dwordx4 v5, s[40:43], s56 offen lds
  s_mul_i32 s50, s7, 65536
  s_lshl_b32 s51, s6, 7
  s_add_u32 s50, s50, s51
  s_mul_i32 s51, s7, 8192
  v_lshrrev_b32 v8, 3, v2
  v_lshlrev_b32 v8, 10, v8
  v_bfe_u32 v9, v2, 4, 1
  v_lshlrev_b32 v9, 2, v9
  v_and_b32 v10, 7, v2
  v_xor_b32 v9, v9, v10
  v_lshl_add_u32 v8, v9, 4, v8
  s_add_u32 m0, s51, 0
  s_add_u32 s52, s50, 0
  buffer_load_dwordx4 v8, s[36:39], s52 offen lds
  s_add_u32 m0, s51, 1024
  s_add_u32 s52, s50, 8192
  buffer_load_dwordx4 v8, s[36:39], s52 offen lds
  s_add_u32 m0, s51, 2048
  s_add_u32 s52, s50, 16384
  buffer_load_dwordx4 v8, s[36:39], s52 offen lds
  s_add_u32 m0, s51, 3072
  s_add_u32 s52, s50, 24576
  buffer_load_dwordx4 v8, s[36:39], s52 offen lds
  s_add_u32 m0, s51, 4096
  s_add_u32 s52, s50, 32768
  buffer_load_dwordx4 v8, s[36:39], s52 offen lds
  s_add_u32 m0, s51, 5120
  s_add_u32 s52, s50, 40960
  buffer_load_dwordx4 v8, s[36:39], s52 offen lds
  s_add_u32 m0, s51, 6144
  s_add_u32 s52, s50, 49152
  buffer_load_dwordx4 v8, s[36:39], s52 offen lds
  s_add_u32 m0, s51, 7168
  s_add_u32 s52, s50, 57344
  buffer_load_dwordx4 v8, s[36:39], s52 offen lds
  v_mov_b32 v160, v6
  buffer_load_dwordx4 v[16:19], v160, s[40:43], s57 offen offset:0
  buffer_load_dwordx4 v[20:23], v160, s[40:43], s57 offen offset:1024
  buffer_load_dwordx4 v[24:27], v160, s[40:43], s57 offen offset:2048
  buffer_load_dwordx4 v[28:31], v160, s[40:43], s57 offen offset:3072
  s_add_u32 s57, s57, 4096
  s_lshl_b32 s53, s5, 16
  s_lshl_b32 s54, s6, 7
  s_add_u32 s53, s53, s54
  s_add_u32 s54, s53, 0
  v_lshrrev_b32 v5, 3, v0
  v_and_b32 v6, 7, v0
  v_lshlrev_b32 v7, 10, v5
  v_lshl_add_u32 v7, v6, 4, v7
  buffer_load_dwordx4 v[12:15], v7, s[32:35], s54 offen
  v_bfe_u32 v8, v2, 2, 2
  v_mad_u32_u24 v11, v4, 8, v8
  v_mul_u32_u24 v11, 128, v11
  v_bfe_u32 v9, v2, 4, 1
  v_lshlrev_b32 v9, 5, v9
  v_and_b32 v8, 3, v2
  v_lshl_add_u32 v9, v8, 3, v9
  v_bfe_u32 v8, v2, 3, 1
  v_lshlrev_b32 v8, 6, v8
  v_xor_b32 v9, v8, v9
  v_add_u32 v11, v11, v9
  s_lshl_b32 s56, s48, 14
  v_add_u32 v11, s56, v11
  v_xor_b32 v10, 64, v11
  v_min_u32 v8, 16, v3
  s_mul_i32 s56, s48, 136
  v_add_u32 v8, s56, v8
  v_lshlrev_b32 v9, 2, v4
  s_waitcnt vmcnt(5)
  v_mov_b32 v163, 1
  ds_write_b32 v162, v163
  v_xor_b32 v162, 4, v162
  s_mov_b32 s58, 0
kb1_kernel_ps:
  ds_read_b32 v163, v162
  s_add_u32 s58, s58, 1
  s_waitcnt lgkmcnt(0)
  v_readfirstlane_b32 s59, v163
  s_cmp_gt_u32 s58, 0x100000
  s_cbranch_scc1 kb1_kernel_pg
  s_cmp_lg_u32 s59, 1
  s_cbranch_scc1 kb1_kernel_ps
kb1_kernel_pg:
  v_add_u32 v1, 0, v8
  v_and_b32 v0, 7, v1
  v_xor_b32 v0, v0, v9
  v_lshlrev_b32 v1, 7, v1
  v_lshl_add_u32 v0, v0, 4, v1
  v_add_u32 v0, 65536, v0
  ds_read_b128 v[80:83], v0
  v_xor_b32 v1, 16, v0
  ds_read_b128 v[84:87], v1
  v_xor_b32 v1, 32, v0
  ds_read_b128 v[88:91], v1
  v_xor_b32 v1, 48, v0
  ds_read_b128 v[92:95], v1
  buffer_load_dwordx4 v[32:35], v160, s[40:43], s57 offen offset:0
  buffer_load_dwordx4 v[36:39], v160, s[40:43], s57 offen offset:1024
  buffer_load_dwordx4 v[40:43], v160, s[40:43], s57 offen offset:2048
  buffer_load_dwordx4 v[44:47], v160, s[40:43], s57 offen offset:3072
  s_add_u32 s57, s57, 4096
  s_waitcnt vmcnt(7) lgkmcnt(0)
  v_cvt_pk_bf16_f32 v80, v80, v81
  v_cvt_pk_bf16_f32 v81, v82, v83
  v_cvt_pk_bf16_f32 v82, v84, v85
  v_cvt_pk_bf16_f32 v83, v86, v87
  v_cvt_pk_bf16_f32 v84, v88, v89
  v_cvt_pk_bf16_f32 v85, v90, v91
  v_cvt_pk_bf16_f32 v86, v92, v93
  v_cvt_pk_bf16_f32 v87, v94, v95
  ds_read_b64_tr_b16 v[88:89], v11 offset:0
  ds_read_b64_tr_b16 v[90:91], v11 offset:512
  ds_read_b64_tr_b16 v[92:93], v10 offset:0
  ds_read_b64_tr_b16 v[94:95], v10 offset:512
  v_mfma_f32_32x32x16_bf16 v[144:159], v[80:83], v[16:19], 0
  v_mfma_f32_32x32x16_bf16 v[144:159], v[84:87], v[20:23], v[144:159]
  buffer_load_dwordx4 v[48:51], v160, s[40:43], s57 offen offset:0
  buffer_load_dwordx4 v[52:55], v160, s[40:43], s57 offen offset:1024
  v_add_u32 v1, 17, v8
  v_and_b32 v0, 7, v1
  v_xor_b32 v0, v0, v9
  v_lshlrev_b32 v1, 7, v1
  v_lshl_add_u32 v0, v0, 4, v1
  v_add_u32 v0, 65536, v0
  ds_read_b128 v[96:99], v0
  v_xor_b32 v1, 16, v0
  ds_read_b128 v[100:103], v1
  v_xor_b32 v1, 32, v0
  ds_read_b128 v[104:107], v1
  v_xor_b32 v1, 48, v0
  ds_read_b128 v[108:111], v1
  s_nop 3
  v_add_f32 v1, 0x358637bd, v152
  v_rcp_f32 v0, v1
  s_nop 0
  v_mov_b32 v1, v0
  v_pk_mul_f32 v[144:145], v[144:145], v[0:1]
  v_pk_mul_f32 v[146:147], v[146:147], v[0:1]
  v_pk_mul_f32 v[148:149], v[148:149], v[0:1]
  v_pk_mul_f32 v[150:151], v[150:151], v[0:1]
  v_cvt_pk_bf16_f32 v16, v144, v145
  v_cvt_pk_bf16_f32 v17, v146, v147
  v_cvt_pk_bf16_f32 v18, v148, v149
  v_cvt_pk_bf16_f32 v19, v150, v151
  s_waitcnt lgkmcnt(4)
  s_nop 0
  v_mfma_f32_32x32x16_bf16 v[112:127], v[88:91], v[16:19], 0
  v_mfma_f32_32x32x16_bf16 v[128:143], v[92:95], v[16:19], 0
  s_waitcnt vmcnt(6) lgkmcnt(0)
  v_cvt_pk_bf16_f32 v96, v96, v97
  v_cvt_pk_bf16_f32 v97, v98, v99
  v_cvt_pk_bf16_f32 v98, v100, v101
  v_cvt_pk_bf16_f32 v99, v102, v103
  v_cvt_pk_bf16_f32 v100, v104, v105
  v_cvt_pk_bf16_f32 v101, v106, v107
  v_cvt_pk_bf16_f32 v102, v108, v109
  v_cvt_pk_bf16_f32 v103, v110, v111
  ds_read_b64_tr_b16 v[104:105], v11 offset:2048
  ds_read_b64_tr_b16 v[106:107], v11 offset:2560
  ds_read_b64_tr_b16 v[108:109], v10 offset:2048
  ds_read_b64_tr_b16 v[110:111], v10 offset:2560
  v_mfma_f32_32x32x16_bf16 v[144:159], v[96:99], v[24:27], 0
  v_mfma_f32_32x32x16_bf16 v[144:159], v[100:103], v[28:31], v[144:159]
  buffer_load_dwordx4 v[56:59], v160, s[40:43], s57 offen offset:2048
  buffer_load_dwordx4 v[60:63], v160, s[40:43], s57 offen offset:3072
  s_add_u32 s57, s57, 4096
  v_add_u32 v1, 34, v8
  v_and_b32 v0, 7, v1
  v_xor_b32 v0, v0, v9
  v_lshlrev_b32 v1, 7, v1
  v_lshl_add_u32 v0, v0, 4, v1
  v_add_u32 v0, 65536, v0
  ds_read_b128 v[80:83], v0
  v_xor_b32 v1, 16, v0
  ds_read_b128 v[84:87], v1
  v_xor_b32 v1, 32, v0
  ds_read_b128 v[88:91], v1
  v_xor_b32 v1, 48, v0
  ds_read_b128 v[92:95], v1
  s_nop 3
  v_add_f32 v1, 0x358637bd, v152
  v_rcp_f32 v0, v1
  s_nop 0
  v_mov_b32 v1, v0
  v_pk_mul_f32 v[144:145], v[144:145], v[0:1]
  v_pk_mul_f32 v[146:147], v[146:147], v[0:1]
  v_pk_mul_f32 v[148:149], v[148:149], v[0:1]
  v_pk_mul_f32 v[150:151], v[150:151], v[0:1]
  v_cvt_pk_bf16_f32 v24, v144, v145
  v_cvt_pk_bf16_f32 v25, v146, v147
  v_cvt_pk_bf16_f32 v26, v148, v149
  v_cvt_pk_bf16_f32 v27, v150, v151
  s_waitcnt lgkmcnt(4)
  s_nop 0
  v_mfma_f32_32x32x16_bf16 v[112:127], v[104:107], v[24:27], v[112:127]
  v_mfma_f32_32x32x16_bf16 v[128:143], v[108:111], v[24:27], v[128:143]
  s_waitcnt vmcnt(6) lgkmcnt(0)
  v_cvt_pk_bf16_f32 v80, v80, v81
  v_cvt_pk_bf16_f32 v81, v82, v83
  v_cvt_pk_bf16_f32 v82, v84, v85
  v_cvt_pk_bf16_f32 v83, v86, v87
  v_cvt_pk_bf16_f32 v84, v88, v89
  v_cvt_pk_bf16_f32 v85, v90, v91
  v_cvt_pk_bf16_f32 v86, v92, v93
  v_cvt_pk_bf16_f32 v87, v94, v95
  ds_read_b64_tr_b16 v[88:89], v11 offset:4096
  ds_read_b64_tr_b16 v[90:91], v11 offset:4608
  ds_read_b64_tr_b16 v[92:93], v10 offset:4096
  ds_read_b64_tr_b16 v[94:95], v10 offset:4608
  v_mfma_f32_32x32x16_bf16 v[144:159], v[80:83], v[32:35], 0
  v_mfma_f32_32x32x16_bf16 v[144:159], v[84:87], v[36:39], v[144:159]
  buffer_load_dwordx4 v[64:67], v160, s[40:43], s57 offen offset:0
  buffer_load_dwordx4 v[68:71], v160, s[40:43], s57 offen offset:1024
  v_add_u32 v1, 51, v8
  v_and_b32 v0, 7, v1
  v_xor_b32 v0, v0, v9
  v_lshlrev_b32 v1, 7, v1
  v_lshl_add_u32 v0, v0, 4, v1
  v_add_u32 v0, 65536, v0
  ds_read_b128 v[96:99], v0
  v_xor_b32 v1, 16, v0
  ds_read_b128 v[100:103], v1
  v_xor_b32 v1, 32, v0
  ds_read_b128 v[104:107], v1
  v_xor_b32 v1, 48, v0
  ds_read_b128 v[108:111], v1
  s_nop 3
  v_add_f32 v1, 0x358637bd, v152
  v_rcp_f32 v0, v1
  s_nop 0
  v_mov_b32 v1, v0
  v_pk_mul_f32 v[144:145], v[144:145], v[0:1]
  v_pk_mul_f32 v[146:147], v[146:147], v[0:1]
  v_pk_mul_f32 v[148:149], v[148:149], v[0:1]
  v_pk_mul_f32 v[150:151], v[150:151], v[0:1]
  v_cvt_pk_bf16_f32 v32, v144, v145
  v_cvt_pk_bf16_f32 v33, v146, v147
  v_cvt_pk_bf16_f32 v34, v148, v149
  v_cvt_pk_bf16_f32 v35, v150, v151
  s_waitcnt lgkmcnt(4)
  s_nop 0
  v_mfma_f32_32x32x16_bf16 v[112:127], v[88:91], v[32:35], v[112:127]
  v_mfma_f32_32x32x16_bf16 v[128:143], v[92:95], v[32:35], v[128:143]
  s_waitcnt vmcnt(6) lgkmcnt(0)
  v_cvt_pk_bf16_f32 v96, v96, v97
  v_cvt_pk_bf16_f32 v97, v98, v99
  v_cvt_pk_bf16_f32 v98, v100, v101
  v_cvt_pk_bf16_f32 v99, v102, v103
  v_cvt_pk_bf16_f32 v100, v104, v105
  v_cvt_pk_bf16_f32 v101, v106, v107
  v_cvt_pk_bf16_f32 v102, v108, v109
  v_cvt_pk_bf16_f32 v103, v110, v111
  ds_read_b64_tr_b16 v[104:105], v11 offset:6144
  ds_read_b64_tr_b16 v[106:107], v11 offset:6656
  ds_read_b64_tr_b16 v[108:109], v10 offset:6144
  ds_read_b64_tr_b16 v[110:111], v10 offset:6656
  v_mfma_f32_32x32x16_bf16 v[144:159], v[96:99], v[40:43], 0
  v_mfma_f32_32x32x16_bf16 v[144:159], v[100:103], v[44:47], v[144:159]
  buffer_load_dwordx4 v[72:75], v160, s[40:43], s57 offen offset:2048
  buffer_load_dwordx4 v[76:79], v160, s[40:43], s57 offen offset:3072
  s_add_u32 s57, s57, 4096
  v_add_u32 v1, 68, v8
  v_and_b32 v0, 7, v1
  v_xor_b32 v0, v0, v9
  v_lshlrev_b32 v1, 7, v1
  v_lshl_add_u32 v0, v0, 4, v1
  v_add_u32 v0, 65536, v0
  ds_read_b128 v[80:83], v0
  v_xor_b32 v1, 16, v0
  ds_read_b128 v[84:87], v1
  v_xor_b32 v1, 32, v0
  ds_read_b128 v[88:91], v1
  v_xor_b32 v1, 48, v0
  ds_read_b128 v[92:95], v1
  s_nop 3
  v_add_f32 v1, 0x358637bd, v152
  v_rcp_f32 v0, v1
  s_nop 0
  v_mov_b32 v1, v0
  v_pk_mul_f32 v[144:145], v[144:145], v[0:1]
  v_pk_mul_f32 v[146:147], v[146:147], v[0:1]
  v_pk_mul_f32 v[148:149], v[148:149], v[0:1]
  v_pk_mul_f32 v[150:151], v[150:151], v[0:1]
  v_cvt_pk_bf16_f32 v40, v144, v145
  v_cvt_pk_bf16_f32 v41, v146, v147
  v_cvt_pk_bf16_f32 v42, v148, v149
  v_cvt_pk_bf16_f32 v43, v150, v151
  s_waitcnt lgkmcnt(4)
  s_nop 0
  v_mfma_f32_32x32x16_bf16 v[112:127], v[104:107], v[40:43], v[112:127]
  v_mfma_f32_32x32x16_bf16 v[128:143], v[108:111], v[40:43], v[128:143]
  s_waitcnt vmcnt(6) lgkmcnt(0)
  v_cvt_pk_bf16_f32 v80, v80, v81
  v_cvt_pk_bf16_f32 v81, v82, v83
  v_cvt_pk_bf16_f32 v82, v84, v85
  v_cvt_pk_bf16_f32 v83, v86, v87
  v_cvt_pk_bf16_f32 v84, v88, v89
  v_cvt_pk_bf16_f32 v85, v90, v91
  v_cvt_pk_bf16_f32 v86, v92, v93
  v_cvt_pk_bf16_f32 v87, v94, v95
  ds_read_b64_tr_b16 v[88:89], v11 offset:8192
  ds_read_b64_tr_b16 v[90:91], v11 offset:8704
  ds_read_b64_tr_b16 v[92:93], v10 offset:8192
  ds_read_b64_tr_b16 v[94:95], v10 offset:8704
  v_mfma_f32_32x32x16_bf16 v[144:159], v[80:83], v[48:51], 0
  v_mfma_f32_32x32x16_bf16 v[144:159], v[84:87], v[52:55], v[144:159]
  v_add_u32 v1, 85, v8
  v_and_b32 v0, 7, v1
  v_xor_b32 v0, v0, v9
  v_lshlrev_b32 v1, 7, v1
  v_lshl_add_u32 v0, v0, 4, v1
  v_add_u32 v0, 65536, v0
  ds_read_b128 v[96:99], v0
  v_xor_b32 v1, 16, v0
  ds_read_b128 v[100:103], v1
  v_xor_b32 v1, 32, v0
  ds_read_b128 v[104:107], v1
  v_xor_b32 v1, 48, v0
  ds_read_b128 v[108:111], v1
  s_nop 3
  v_add_f32 v1, 0x358637bd, v152
  v_rcp_f32 v0, v1
  s_nop 0
  v_mov_b32 v1, v0
  v_pk_mul_f32 v[144:145], v[144:145], v[0:1]
  v_pk_mul_f32 v[146:147], v[146:147], v[0:1]
  v_pk_mul_f32 v[148:149], v[148:149], v[0:1]
  v_pk_mul_f32 v[150:151], v[150:151], v[0:1]
  v_cvt_pk_bf16_f32 v48, v144, v145
  v_cvt_pk_bf16_f32 v49, v146, v147
  v_cvt_pk_bf16_f32 v50, v148, v149
  v_cvt_pk_bf16_f32 v51, v150, v151
  s_waitcnt lgkmcnt(4)
  s_nop 0
  v_mfma_f32_32x32x16_bf16 v[112:127], v[88:91], v[48:51], v[112:127]
  v_mfma_f32_32x32x16_bf16 v[128:143], v[92:95], v[48:51], v[128:143]
  s_waitcnt vmcnt(4) lgkmcnt(0)
  v_cvt_pk_bf16_f32 v96, v96, v97
  v_cvt_pk_bf16_f32 v97, v98, v99
  v_cvt_pk_bf16_f32 v98, v100, v101
  v_cvt_pk_bf16_f32 v99, v102, v103
  v_cvt_pk_bf16_f32 v100, v104, v105
  v_cvt_pk_bf16_f32 v101, v106, v107
  v_cvt_pk_bf16_f32 v102, v108, v109
  v_cvt_pk_bf16_f32 v103, v110, v111
  ds_read_b64_tr_b16 v[104:105], v11 offset:10240
  ds_read_b64_tr_b16 v[106:107], v11 offset:10752
  ds_read_b64_tr_b16 v[108:109], v10 offset:10240
  ds_read_b64_tr_b16 v[110:111], v10 offset:10752
  v_mfma_f32_32x32x16_bf16 v[144:159], v[96:99], v[56:59], 0
  v_mfma_f32_32x32x16_bf16 v[144:159], v[100:103], v[60:63], v[144:159]
  v_add_u32 v1, 102, v8
  v_and_b32 v0, 7, v1
  v_xor_b32 v0, v0, v9
  v_lshlrev_b32 v1, 7, v1
  v_lshl_add_u32 v0, v0, 4, v1
  v_add_u32 v0, 65536, v0
  ds_read_b128 v[80:83], v0
  v_xor_b32 v1, 16, v0
  ds_read_b128 v[84:87], v1
  v_xor_b32 v1, 32, v0
  ds_read_b128 v[88:91], v1
  v_xor_b32 v1, 48, v0
  ds_read_b128 v[92:95], v1
  s_nop 3
  v_add_f32 v1, 0x358637bd, v152
  v_rcp_f32 v0, v1
  s_nop 0
  v_mov_b32 v1, v0
  v_pk_mul_f32 v[144:145], v[144:145], v[0:1]
  v_pk_mul_f32 v[146:147], v[146:147], v[0:1]
  v_pk_mul_f32 v[148:149], v[148:149], v[0:1]
  v_pk_mul_f32 v[150:151], v[150:151], v[0:1]
  v_cvt_pk_bf16_f32 v56, v144, v145
  v_cvt_pk_bf16_f32 v57, v146, v147
  v_cvt_pk_bf16_f32 v58, v148, v149
  v_cvt_pk_bf16_f32 v59, v150, v151
  s_waitcnt lgkmcnt(4)
  s_nop 0
  v_mfma_f32_32x32x16_bf16 v[112:127], v[104:107], v[56:59], v[112:127]
  v_mfma_f32_32x32x16_bf16 v[128:143], v[108:111], v[56:59], v[128:143]
  s_waitcnt vmcnt(2) lgkmcnt(0)
  v_cvt_pk_bf16_f32 v80, v80, v81
  v_cvt_pk_bf16_f32 v81, v82, v83
  v_cvt_pk_bf16_f32 v82, v84, v85
  v_cvt_pk_bf16_f32 v83, v86, v87
  v_cvt_pk_bf16_f32 v84, v88, v89
  v_cvt_pk_bf16_f32 v85, v90, v91
  v_cvt_pk_bf16_f32 v86, v92, v93
  v_cvt_pk_bf16_f32 v87, v94, v95
  ds_read_b64_tr_b16 v[88:89], v11 offset:12288
  ds_read_b64_tr_b16 v[90:91], v11 offset:12800
  ds_read_b64_tr_b16 v[92:93], v10 offset:12288
  ds_read_b64_tr_b16 v[94:95], v10 offset:12800
  v_mfma_f32_32x32x16_bf16 v[144:159], v[80:83], v[64:67], 0
  v_mfma_f32_32x32x16_bf16 v[144:159], v[84:87], v[68:71], v[144:159]
  v_add_u32 v1, 119, v8
  v_and_b32 v0, 7, v1
  v_xor_b32 v0, v0, v9
  v_lshlrev_b32 v1, 7, v1
  v_lshl_add_u32 v0, v0, 4, v1
  v_add_u32 v0, 65536, v0
  ds_read_b128 v[96:99], v0
  v_xor_b32 v1, 16, v0
  ds_read_b128 v[100:103], v1
  v_xor_b32 v1, 32, v0
  ds_read_b128 v[104:107], v1
  v_xor_b32 v1, 48, v0
  ds_read_b128 v[108:111], v1
  s_nop 3
  v_add_f32 v1, 0x358637bd, v152
  v_rcp_f32 v0, v1
  s_nop 0
  v_mov_b32 v1, v0
  v_pk_mul_f32 v[144:145], v[144:145], v[0:1]
  v_pk_mul_f32 v[146:147], v[146:147], v[0:1]
  v_pk_mul_f32 v[148:149], v[148:149], v[0:1]
  v_pk_mul_f32 v[150:151], v[150:151], v[0:1]
  v_cvt_pk_bf16_f32 v64, v144, v145
  v_cvt_pk_bf16_f32 v65, v146, v147
  v_cvt_pk_bf16_f32 v66, v148, v149
  v_cvt_pk_bf16_f32 v67, v150, v151
  s_waitcnt lgkmcnt(4)
  s_nop 0
  v_mfma_f32_32x32x16_bf16 v[112:127], v[88:91], v[64:67], v[112:127]
  v_mfma_f32_32x32x16_bf16 v[128:143], v[92:95], v[64:67], v[128:143]
  s_waitcnt vmcnt(0) lgkmcnt(0)
  v_cvt_pk_bf16_f32 v96, v96, v97
  v_cvt_pk_bf16_f32 v97, v98, v99
  v_cvt_pk_bf16_f32 v98, v100, v101
  v_cvt_pk_bf16_f32 v99, v102, v103
  v_cvt_pk_bf16_f32 v100, v104, v105
  v_cvt_pk_bf16_f32 v101, v106, v107
  v_cvt_pk_bf16_f32 v102, v108, v109
  v_cvt_pk_bf16_f32 v103, v110, v111
  ds_read_b64_tr_b16 v[104:105], v11 offset:14336
  ds_read_b64_tr_b16 v[106:107], v11 offset:14848
  ds_read_b64_tr_b16 v[108:109], v10 offset:14336
  ds_read_b64_tr_b16 v[110:111], v10 offset:14848
  v_mfma_f32_32x32x16_bf16 v[144:159], v[96:99], v[72:75], 0
  v_mfma_f32_32x32x16_bf16 v[144:159], v[100:103], v[76:79], v[144:159]
  s_nop 7
  s_nop 3
  v_add_f32 v1, 0x358637bd, v152
  v_rcp_f32 v0, v1
  s_nop 0
  v_mov_b32 v1, v0
  v_pk_mul_f32 v[144:145], v[144:145], v[0:1]
  v_pk_mul_f32 v[146:147], v[146:147], v[0:1]
  v_pk_mul_f32 v[148:149], v[148:149], v[0:1]
  v_pk_mul_f32 v[150:151], v[150:151], v[0:1]
  v_cvt_pk_bf16_f32 v72, v144, v145
  v_cvt_pk_bf16_f32 v73, v146, v147
  v_cvt_pk_bf16_f32 v74, v148, v149
  v_cvt_pk_bf16_f32 v75, v150, v151
  s_waitcnt lgkmcnt(0)
  s_nop 0
  v_mfma_f32_32x32x16_bf16 v[112:127], v[104:107], v[72:75], v[112:127]
  v_mfma_f32_32x32x16_bf16 v[128:143], v[108:111], v[72:75], v[128:143]
  s_mov_b32 s60, s18
  s_mov_b32 s61, s19
  s_mov_b32 s62, 1409024
  s_mov_b32 s63, 0x00020000
  s_sub_u32 s68, s7, 0
  s_cmp_ge_u32 s68, 6
  s_cbranch_scc1 pf5
  s_lshl_b32 s68, s68, 12
  v_lshlrev_b32 v161, 6, v2
  v_add_u32 v161, s68, v161
  s_lshr_b32 s69, s2, 3
  s_mul_i32 s69, s69, 49152
  buffer_load_dword v162, v161, s[60:63], s69 offen
  s_add_u32 s69, s69, 24576
  buffer_load_dword v163, v161, s[60:63], s69 offen
pf5:
  s_barrier
  s_mul_i32 s56, s48, 17408
  s_mul_i32 s57, s49, 8704
  s_add_u32 s56, s56, s57
  s_add_u32 s56, s56, 65536
  v_mul_u32_u24 v8, 272, v3
  v_lshl_add_u32 v8, v4, 4, v8
  v_add_u32 v8, s56, v8
  v_mul_u32_u24 v9, 272, v5
  v_lshl_add_u32 v9, v6, 5, v9
  v_add_u32 v9, 65536, v9
  s_add_u32 s54, s53, 5242880
  s_nop 7
  ds_write_b128 v8, v[112:115] offset:0
  ds_write_b128 v8, v[116:119] offset:32
  ds_write_b128 v8, v[120:123] offset:64
  ds_write_b128 v8, v[124:127] offset:96
  ds_write_b128 v8, v[128:131] offset:128
  ds_write_b128 v8, v[132:135] offset:160
  ds_write_b128 v8, v[136:139] offset:192
  ds_write_b128 v8, v[140:143] offset:224
  s_waitcnt lgkmcnt(0)
  s_barrier
  ds_read_b128 v[16:19], v9 offset:0
  ds_read_b128 v[20:23], v9 offset:16
  ds_read_b128 v[24:27], v9 offset:17408
  ds_read_b128 v[28:31], v9 offset:17424
  ds_read_b128 v[32:35], v9 offset:34816
  ds_read_b128 v[36:39], v9 offset:34832
  ds_read_b128 v[40:43], v9 offset:52224
  ds_read_b128 v[44:47], v9 offset:52240
  v_lshlrev_b32 v48, 16, v12
  v_and_b32 v49, 0xffff0000, v12
  v_lshlrev_b32 v50, 16, v13
  v_and_b32 v51, 0xffff0000, v13
  v_lshlrev_b32 v52, 16, v14
  v_and_b32 v53, 0xffff0000, v14
  v_lshlrev_b32 v54, 16, v15
  v_and_b32 v55, 0xffff0000, v15
  s_waitcnt lgkmcnt(0)
  v_pk_add_f32 v[16:17], v[16:17], v[24:25]
  v_pk_add_f32 v[18:19], v[18:19], v[26:27]
  v_pk_add_f32 v[20:21], v[20:21], v[28:29]
  v_pk_add_f32 v[22:23], v[22:23], v[30:31]
  v_pk_add_f32 v[32:33], v[32:33], v[40:41]
  v_pk_add_f32 v[34:35], v[34:35], v[42:43]
  v_pk_add_f32 v[36:37], v[36:37], v[44:45]
  v_pk_add_f32 v[38:39], v[38:39], v[46:47]
  v_pk_add_f32 v[16:17], v[16:17], v[32:33]
  v_pk_add_f32 v[18:19], v[18:19], v[34:35]
  v_pk_add_f32 v[20:21], v[20:21], v[36:37]
  v_pk_add_f32 v[22:23], v[22:23], v[38:39]
  v_pk_add_f32 v[16:17], v[16:17], v[48:49]
  v_pk_add_f32 v[18:19], v[18:19], v[50:51]
  v_pk_add_f32 v[20:21], v[20:21], v[52:53]
  v_pk_add_f32 v[22:23], v[22:23], v[54:55]
  v_cvt_pk_bf16_f32 v24, v16, v17
  v_cvt_pk_bf16_f32 v25, v18, v19
  v_cvt_pk_bf16_f32 v26, v20, v21
  v_cvt_pk_bf16_f32 v27, v22, v23
  buffer_store_dwordx4 v[24:27], v7, s[40:43], s54 offen
  s_cmp_lg_u32 s7, 0
  s_cbranch_scc1 kb1_kernel_ns
  s_cmp_ge_u32 s6, 4
  s_cbranch_scc1 kb1_kernel_ns
  s_lshl_b32 s56, s5, 11
  s_lshl_b32 s57, s6, 9
  s_add_u32 s56, s56, s57
  s_add_u32 s56, s56, 20971520
  v_lshlrev_b32 v8, 3, v2
  v_mov_b32 v10, -1
  v_mov_b32 v11, -1
  buffer_store_dwordx2 v[10:11], v8, s[40:43], s56 offen
kb1_kernel_ns:
kb1_kernel_end:
  s_endpgm
.globl kb2_kernel
.p2align 8
.type kb2_kernel,@function
kb2_kernel:
  s_cmp_ge_u32 s2, 256
  s_cbranch_scc1 kb2_kernel_end
  s_load_dwordx16 s[8:23], s[0:1], 0
  s_load_dwordx8 s[24:31], s[0:1], 64
  s_and_b32 s3, s2, 7
  s_lshr_b32 s4, s2, 3
  s_lshl_b32 s5, s3, 2
  s_lshr_b32 s6, s4, 3
  s_add_u32 s5, s5, s6
  s_and_b32 s6, s4, 7
  v_lshrrev_b32 v1, 6, v0
  v_and_b32 v2, 63, v0
  v_readfirstlane_b32 s7, v1
  v_and_b32 v3, 31, v0
  v_bfe_u32 v4, v0, 5, 1
  s_waitcnt lgkmcnt(0)
  s_mov_b32 s36, s18
  s_mov_b32 s37, s19
  s_mov_b32 s38, 1409024
  s_mov_b32 s39, 0x00020000
  s_mov_b32 s40, s30
  s_mov_b32 s41, s31
  s_mov_b32 s42, 268435456
  s_mov_b32 s43, 0x00020000
  s_cmp_ge_u32 s7, 6
  s_cselect_b32 s49, 1, 0
  s_mul_i32 s48, s49, 6
  s_sub_u32 s48, s7, s48
  s_lshr_b32 s51, s7, 2
  s_lshr_b32 s56, s6, 2
  s_mul_i32 s50, s56, 1376
  s_and_b32 s56, s6, 3
  s_mul_i32 s56, s56, 384
  s_add_u32 s50, s50, s56
  s_lshl_b32 s52, s5, 16
  s_add_u32 s52, s52, 5242880
  v_lshrrev_b32 v5, 3, v0
  v_and_b32 v6, 7, v0
  v_lshlrev_b32 v7, 10, v5
  v_lshl_add_u32 v7, v6, 4, v7
  s_cmp_ge_u32 s7, 8
  s_cbranch_scc1 kb2_kernel_nox
  buffer_load_dwordx4 v[16:19], v7, s[40:43], s52 offen offset:0
  buffer_load_dwordx4 v[20:23], v7, s[40:43], s52 offen offset:128
  buffer_load_dwordx4 v[24:27], v7, s[40:43], s52 offen offset:256
  buffer_load_dwordx4 v[28:31], v7, s[40:43], s52 offen offset:384
  buffer_load_dwordx4 v[32:35], v7, s[40:43], s52 offen offset:512
  buffer_load_dwordx4 v[36:39], v7, s[40:43], s52 offen offset:640
  buffer_load_dwordx4 v[40:43], v7, s[40:43], s52 offen offset:768
  buffer_load_dwordx4 v[44:47], v7, s[40:43], s52 offen offset:896
kb2_kernel_nox:
  s_and_b32 s53, s7, 3
  s_lshl_b32 s54, s53, 11
  s_lshl_b32 s53, s53, 4
  v_lshrrev_b32 v8, 3, v2
  v_add_u32 v8, s53, v8
  v_mul_u32_u24 v8, 2752, v8
  v_bfe_u32 v9, v2, 4, 1
  v_lshlrev_b32 v9, 2, v9
  v_and_b32 v10, 7, v2
  v_xor_b32 v9, v9, v10
  v_lshl_add_u32 v8, v9, 4, v8
  v_add_u32 v8, s50, v8
  v_add_u32 v9, 20992, v8
  s_add_u32 s54, s54, 65536
  s_cmp_lt_u32 s7, 8
  s_cbranch_scc1 kb2_kernel_d1
  s_add_u32 m0, s54, 0
  s_mov_b32 s55, 0
  buffer_load_dwordx4 v8, s[36:39], s55 offen lds
  buffer_load_dwordx4 v9, s[36:39], s55 offen offset:1024 lds
  s_add_u32 m0, s54, 8192
  s_mov_b32 s55, 128
  buffer_load_dwordx4 v8, s[36:39], s55 offen lds
  buffer_load_dwordx4 v9, s[36:39], s55 offen offset:1024 lds
  s_add_u32 m0, s54, 16384
  s_mov_b32 s55, 256
  buffer_load_dwordx4 v8, s[36:39], s55 offen lds
  buffer_load_dwordx4 v9, s[36:39], s55 offen offset:1024 lds
  s_add_u32 m0, s54, 24576
  s_mov_b32 s55, 176128
  buffer_load_dwordx4 v8, s[36:39], s55 offen lds
  buffer_load_dwordx4 v9, s[36:39], s55 offen offset:1024 lds
  s_add_u32 m0, s54, 32768
  s_mov_b32 s55, 176256
  buffer_load_dwordx4 v8, s[36:39], s55 offen lds
  buffer_load_dwordx4 v9, s[36:39], s55 offen offset:1024 lds
  s_add_u32 m0, s54, 40960
  s_mov_b32 s55, 176384
  buffer_load_dwordx4 v8, s[36:39], s55 offen lds
  buffer_load_dwordx4 v9, s[36:39], s55 offen offset:1024 lds
kb2_kernel_d1:
  s_cmp_ge_u32 s7, 8
  s_cbranch_scc1 kb2_kernel_noln
  s_waitcnt vmcnt(0)
  v_lshlrev_b32 v48, 16, v16
  v_and_b32 v49, 0xffff0000, v16
  v_lshlrev_b32 v50, 16, v17
  v_and_b32 v51, 0xffff0000, v17
  v_lshlrev_b32 v52, 16, v18
  v_and_b32 v53, 0xffff0000, v18
  v_lshlrev_b32 v54, 16, v19
  v_and_b32 v55, 0xffff0000, v19
  v_lshlrev_b32 v56, 16, v20
  v_and_b32 v57, 0xffff0000, v20
  v_lshlrev_b32 v58, 16, v21
  v_and_b32 v59, 0xffff0000, v21
  v_lshlrev_b32 v60, 16, v22
  v_and_b32 v61, 0xffff0000, v22
  v_lshlrev_b32 v62, 16, v23
  v_and_b32 v63, 0xffff0000, v23
  v_lshlrev_b32 v64, 16, v24
  v_and_b32 v65, 0xffff0000, v24
  v_lshlrev_b32 v66, 16, v25
  v_and_b32 v67, 0xffff0000, v25
  v_lshlrev_b32 v68, 16, v26
  v_and_b32 v69, 0xffff0000, v26
  v_lshlrev_b32 v70, 16, v27
  v_and_b32 v71, 0xffff0000, v27
  v_lshlrev_b32 v72, 16, v28
  v_and_b32 v73, 0xffff0000, v28
  v_lshlrev_b32 v74, 16, v29
  v_and_b32 v75, 0xffff0000, v29
  v_lshlrev_b32 v76, 16, v30
  v_and_b32 v77, 0xffff0000, v30
  v_lshlrev_b32 v78, 16, v31
  v_and_b32 v79, 0xffff0000, v31
  v_lshlrev_b32 v80, 16, v32
  v_and_b32 v81, 0xffff0000, v32
  v_lshlrev_b32 v82, 16, v33
  v_and_b32 v83, 0xffff0000, v33
  v_lshlrev_b32 v84, 16, v34
  v_and_b32 v85, 0xffff0000, v34
  v_lshlrev_b32 v86, 16, v35
  v_and_b32 v87, 0xffff0000, v35
  v_lshlrev_b32 v88, 16, v36
  v_and_b32 v89, 0xffff0000, v36
  v_lshlrev_b32 v90, 16, v37
  v_and_b32 v91, 0xffff0000, v37
  v_lshlrev_b32 v92, 16, v38
  v_and_b32 v93, 0xffff0000, v38
  v_lshlrev_b32 v94, 16, v39
  v_and_b32 v95, 0xffff0000, v39
  v_lshlrev_b32 v96, 16, v40
  v_and_b32 v97, 0xffff0000, v40
  v_lshlrev_b32 v98, 16, v41
  v_and_b32 v99, 0xffff0000, v41
  v_lshlrev_b32 v100, 16, v42
  v_and_b32 v101, 0xffff0000, v42
  v_lshlrev_b32 v102, 16, v43
  v_and_b32 v103, 0xffff0000, v43
  v_lshlrev_b32 v104, 16, v44
  v_and_b32 v105, 0xffff0000, v44
  v_lshlrev_b32 v106, 16, v45
  v_and_b32 v107, 0xffff0000, v45
  v_lshlrev_b32 v108, 16, v46
  v_and_b32 v109, 0xffff0000, v46
  v_lshlrev_b32 v110, 16, v47
  v_and_b32 v111, 0xffff0000, v47
  v_pk_add_f32 v[12:13], v[48:49], v[50:51]
  v_pk_mul_f32 v[14:15], v[48:49], v[48:49]
  v_pk_fma_f32 v[14:15], v[50:51], v[50:51], v[14:15]
  v_pk_add_f32 v[12:13], v[12:13], v[52:53]
  v_pk_fma_f32 v[14:15], v[52:53], v[52:53], v[14:15]
  v_pk_add_f32 v[12:13], v[12:13], v[54:55]
  v_pk_fma_f32 v[14:15], v[54:55], v[54:55], v[14:15]
  v_pk_add_f32 v[12:13], v[12:13], v[56:57]
  v_pk_fma_f32 v[14:15], v[56:57], v[56:57], v[14:15]
  v_pk_add_f32 v[12:13], v[12:13], v[58:59]
  v_pk_fma_f32 v[14:15], v[58:59], v[58:59], v[14:15]
  v_pk_add_f32 v[12:13], v[12:13], v[60:61]
  v_pk_fma_f32 v[14:15], v[60:61], v[60:61], v[14:15]
  v_pk_add_f32 v[12:13], v[12:13], v[62:63]
  v_pk_fma_f32 v[14:15], v[62:63], v[62:63], v[14:15]
  v_pk_add_f32 v[12:13], v[12:13], v[64:65]
  v_pk_fma_f32 v[14:15], v[64:65], v[64:65], v[14:15]
  v_pk_add_f32 v[12:13], v[12:13], v[66:67]
  v_pk_fma_f32 v[14:15], v[66:67], v[66:67], v[14:15]
  v_pk_add_f32 v[12:13], v[12:13], v[68:69]
  v_pk_fma_f32 v[14:15], v[68:69], v[68:69], v[14:15]
  v_pk_add_f32 v[12:13], v[12:13], v[70:71]
  v_pk_fma_f32 v[14:15], v[70:71], v[70:71], v[14:15]
  v_pk_add_f32 v[12:13], v[12:13], v[72:73]
  v_pk_fma_f32 v[14:15], v[72:73], v[72:73], v[14:15]
  v_pk_add_f32 v[12:13], v[12:13], v[74:75]
  v_pk_fma_f32 v[14:15], v[74:75], v[74:75], v[14:15]
  v_pk_add_f32 v[12:13], v[12:13], v[76:77]
  v_pk_fma_f32 v[14:15], v[76:77], v[76:77], v[14:15]
  v_pk_add_f32 v[12:13], v[12:13], v[78:79]
  v_pk_fma_f32 v[14:15], v[78:79], v[78:79], v[14:15]
  v_pk_add_f32 v[12:13], v[12:13], v[80:81]
  v_pk_fma_f32 v[14:15], v[80:81], v[80:81], v[14:15]
  v_pk_add_f32 v[12:13], v[12:13], v[82:83]
  v_pk_fma_f32 v[14:15], v[82:83], v[82:83], v[14:15]
  v_pk_add_f32 v[12:13], v[12:13], v[84:85]
  v_pk_fma_f32 v[14:15], v[84:85], v[84:85], v[14:15]
  v_pk_add_f32 v[12:13], v[12:13], v[86:87]
  v_pk_fma_f32 v[14:15], v[86:87], v[86:87], v[14:15]
  v_pk_add_f32 v[12:13], v[12:13], v[88:89]
  v_pk_fma_f32 v[14:15], v[88:89], v[88:89], v[14:15]
  v_pk_add_f32 v[12:13], v[12:13], v[90:91]
  v_pk_fma_f32 v[14:15], v[90:91], v[90:91], v[14:15]
  v_pk_add_f32 v[12:13], v[12:13], v[92:93]
  v_pk_fma_f32 v[14:15], v[92:93], v[92:93], v[14:15]
  v_pk_add_f32 v[12:13], v[12:13], v[94:95]
  v_pk_fma_f32 v[14:15], v[94:95], v[94:95], v[14:15]
  v_pk_add_f32 v[12:13], v[12:13], v[96:97]
  v_pk_fma_f32 v[14:15], v[96:97], v[96:97], v[14:15]
  v_pk_add_f32 v[12:13], v[12:13], v[98:99]
  v_pk_fma_f32 v[14:15], v[98:99], v[98:99], v[14:15]
  v_pk_add_f32 v[12:13], v[12:13], v[100:101]
  v_pk_fma_f32 v[14:15], v[100:101], v[100:101], v[14:15]
  v_pk_add_f32 v[12:13], v[12:13], v[102:103]
  v_pk_fma_f32 v[14:15], v[102:103], v[102:103], v[14:15]
  v_pk_add_f32 v[12:13], v[12:13], v[104:105]
  v_pk_fma_f32 v[14:15], v[104:105], v[104:105], v[14:15]
  v_pk_add_f32 v[12:13], v[12:13], v[106:107]
  v_pk_fma_f32 v[14:15], v[106:107], v[106:107], v[14:15]
  v_pk_add_f32 v[12:13], v[12:13], v[108:109]
  v_pk_fma_f32 v[14:15], v[108:109], v[108:109], v[14:15]
  v_pk_add_f32 v[12:13], v[12:13], v[110:111]
  v_pk_fma_f32 v[14:15], v[110:111], v[110:111], v[14:15]
  v_add_f32 v12, v12, v13
  v_add_f32 v14, v14, v15
  s_nop 1
  v_add_f32_dpp v12, v12, v12 quad_perm:[1,0,3,2] row_mask:0xf bank_mask:0xf
  s_nop 1
  v_add_f32_dpp v12, v12, v12 quad_perm:[2,3,0,1] row_mask:0xf bank_mask:0xf
  s_nop 1
  v_add_f32_dpp v12, v12, v12 row_half_mirror row_mask:0xf bank_mask:0xf
  s_nop 1
  v_add_f32_dpp v14, v14, v14 quad_perm:[1,0,3,2] row_mask:0xf bank_mask:0xf
  s_nop 1
  v_add_f32_dpp v14, v14, v14 quad_perm:[2,3,0,1] row_mask:0xf bank_mask:0xf
  s_nop 1
  v_add_f32_dpp v14, v14, v14 row_half_mirror row_mask:0xf bank_mask:0xf
  v_mul_f32 v12, 0x3b000000, v12
  v_mul_f32 v14, 0x3b000000, v14
  v_fma_f32 v14, -v12, v12, v14
  v_max_f32 v14, 0, v14
  v_add_f32 v14, 0x3727c5ac, v14
  v_rsq_f32 v14, v14
  v_bfe_u32 v10, v5, 1, 3
  v_xor_b32 v10, v10, v6
  v_mul_f32 v12, v12, v14
  v_mov_b32 v15, v14
  v_mul_f32 v12, -1.0, v12
  v_lshlrev_b32 v10, 4, v10
  v_mov_b32 v13, v12
  v_lshl_add_u32 v10, v5, 7, v10
  v_pk_fma_f32 v[48:49], v[48:49], v[14:15], v[12:13]
  v_pk_fma_f32 v[50:51], v[50:51], v[14:15], v[12:13]
  v_pk_fma_f32 v[52:53], v[52:53], v[14:15], v[12:13]
  v_pk_fma_f32 v[54:55], v[54:55], v[14:15], v[12:13]
  v_cvt_pk_bf16_f32 v16, v48, v49
  v_cvt_pk_bf16_f32 v17, v50, v51
  v_cvt_pk_bf16_f32 v18, v52, v53
  v_cvt_pk_bf16_f32 v19, v54, v55
  ds_write_b128 v10, v[16:19] offset:0
  v_pk_fma_f32 v[56:57], v[56:57], v[14:15], v[12:13]
  v_pk_fma_f32 v[58:59], v[58:59], v[14:15], v[12:13]
  v_pk_fma_f32 v[60:61], v[60:61], v[14:15], v[12:13]
  v_pk_fma_f32 v[62:63], v[62:63], v[14:15], v[12:13]
  v_cvt_pk_bf16_f32 v20, v56, v57
  v_cvt_pk_bf16_f32 v21, v58, v59
  v_cvt_pk_bf16_f32 v22, v60, v61
  v_cvt_pk_bf16_f32 v23, v62, v63
  ds_write_b128 v10, v[20:23] offset:8192
  v_pk_fma_f32 v[64:65], v[64:65], v[14:15], v[12:13]
  v_pk_fma_f32 v[66:67], v[66:67], v[14:15], v[12:13]
  v_pk_fma_f32 v[68:69], v[68:69], v[14:15], v[12:13]
  v_pk_fma_f32 v[70:71], v[70:71], v[14:15], v[12:13]
  v_cvt_pk_bf16_f32 v24, v64, v65
  v_cvt_pk_bf16_f32 v25, v66, v67
  v_cvt_pk_bf16_f32 v26, v68, v69
  v_cvt_pk_bf16_f32 v27, v70, v71
  ds_write_b128 v10, v[24:27] offset:16384
  v_pk_fma_f32 v[72:73], v[72:73], v[14:15], v[12:13]
  v_pk_fma_f32 v[74:75], v[74:75], v[14:15], v[12:13]
  v_pk_fma_f32 v[76:77], v[76:77], v[14:15], v[12:13]
  v_pk_fma_f32 v[78:79], v[78:79], v[14:15], v[12:13]
  v_cvt_pk_bf16_f32 v28, v72, v73
  v_cvt_pk_bf16_f32 v29, v74, v75
  v_cvt_pk_bf16_f32 v30, v76, v77
  v_cvt_pk_bf16_f32 v31, v78, v79
  ds_write_b128 v10, v[28:31] offset:24576
  v_pk_fma_f32 v[80:81], v[80:81], v[14:15], v[12:13]
  v_pk_fma_f32 v[82:83], v[82:83], v[14:15], v[12:13]
  v_pk_fma_f32 v[84:85], v[84:85], v[14:15], v[12:13]
  v_pk_fma_f32 v[86:87], v[86:87], v[14:15], v[12:13]
  v_cvt_pk_bf16_f32 v32, v80, v81
  v_cvt_pk_bf16_f32 v33, v82, v83
  v_cvt_pk_bf16_f32 v34, v84, v85
  v_cvt_pk_bf16_f32 v35, v86, v87
  ds_write_b128 v10, v[32:35] offset:32768
  v_pk_fma_f32 v[88:89], v[88:89], v[14:15], v[12:13]
  v_pk_fma_f32 v[90:91], v[90:91], v[14:15], v[12:13]
  v_pk_fma_f32 v[92:93], v[92:93], v[14:15], v[12:13]
  v_pk_fma_f32 v[94:95], v[94:95], v[14:15], v[12:13]
  v_cvt_pk_bf16_f32 v36, v88, v89
  v_cvt_pk_bf16_f32 v37, v90, v91
  v_cvt_pk_bf16_f32 v38, v92, v93
  v_cvt_pk_bf16_f32 v39, v94, v95
  ds_write_b128 v10, v[36:39] offset:40960
  v_pk_fma_f32 v[96:97], v[96:97], v[14:15], v[12:13]
  v_pk_fma_f32 v[98:99], v[98:99], v[14:15], v[12:13]
  v_pk_fma_f32 v[100:101], v[100:101], v[14:15], v[12:13]
  v_pk_fma_f32 v[102:103], v[102:103], v[14:15], v[12:13]
  v_cvt_pk_bf16_f32 v40, v96, v97
  v_cvt_pk_bf16_f32 v41, v98, v99
  v_cvt_pk_bf16_f32 v42, v100, v101
  v_cvt_pk_bf16_f32 v43, v102, v103
  ds_write_b128 v10, v[40:43] offset:49152
  v_pk_fma_f32 v[104:105], v[104:105], v[14:15], v[12:13]
  v_pk_fma_f32 v[106:107], v[106:107], v[14:15], v[12:13]
  v_pk_fma_f32 v[108:109], v[108:109], v[14:15], v[12:13]
  v_pk_fma_f32 v[110:111], v[110:111], v[14:15], v[12:13]
  v_cvt_pk_bf16_f32 v44, v104, v105
  v_cvt_pk_bf16_f32 v45, v106, v107
  v_cvt_pk_bf16_f32 v46, v108, v109
  v_cvt_pk_bf16_f32 v47, v110, v111
  ds_write_b128 v10, v[44:47] offset:57344
kb2_kernel_noln:
  s_and_b32 s56, s48, 1
  s_lshl_b32 s56, s56, 6
  v_bfe_u32 v5, v2, 2, 2
  v_mad_u32_u24 v11, v4, 8, v5
  v_mul_u32_u24 v11, 128, v11
  v_bfe_u32 v6, v2, 4, 1
  v_lshlrev_b32 v6, 5, v6
  v_and_b32 v5, 3, v2
  v_lshl_add_u32 v6, v5, 3, v6
  v_add_u32 v6, s56, v6
  v_bfe_u32 v5, v2, 3, 1
  v_lshlrev_b32 v5, 6, v5
  v_xor_b32 v6, v5, v6
  v_add_u32 v11, v11, v6
  s_lshr_b32 s56, s48, 1
  s_lshl_b32 s56, s56, 13
  s_add_u32 s56, s56, 65536
  v_add_u32 v11, s56, v11
  v_add_u32 v10, 49152, v11
  s_lshl_b32 s56, s49, 12
  v_lshlrev_b32 v5, 7, v3
  v_add_u32 v5, s56, v5
  v_bfe_u32 v6, v3, 1, 3
  v_xor_b32 v6, v6, v4
  v_xor_b32 v7, 0, v6
  v_lshl_add_u32 v12, v7, 4, v5
  v_xor_b32 v7, 2, v6
  v_lshl_add_u32 v13, v7, 4, v5
  v_xor_b32 v7, 4, v6
  v_lshl_add_u32 v14, v7, 4, v5
  v_xor_b32 v7, 6, v6
  v_lshl_add_u32 v15, v7, 4, v5
  s_waitcnt vmcnt(6) lgkmcnt(0)
  s_barrier
  ds_read_b64_tr_b16 v[16:17], v11 offset:0
  ds_read_b64_tr_b16 v[18:19], v11 offset:512
  ds_read_b128 v[32:35], v12 offset:0
  ds_read_b64_tr_b16 v[20:21], v11 offset:2048
  ds_read_b64_tr_b16 v[22:23], v11 offset:2560
  ds_read_b128 v[36:39], v13 offset:0
  ds_read_b64_tr_b16 v[24:25], v11 offset:4096
  ds_read_b64_tr_b16 v[26:27], v11 offset:4608
  ds_read_b128 v[40:43], v14 offset:0
  ds_read_b64_tr_b16 v[28:29], v11 offset:6144
  ds_read_b64_tr_b16 v[30:31], v11 offset:6656
  ds_read_b128 v[44:47], v15 offset:0
  s_cmp_lt_u32 s7, 8
  s_cbranch_scc1 kb2_kernel_d2
  s_add_u32 m0, s54, 49152
  s_mov_b32 s55, 352256
  buffer_load_dwordx4 v8, s[36:39], s55 offen lds
  buffer_load_dwordx4 v9, s[36:39], s55 offen offset:1024 lds
  s_add_u32 m0, s54, 57344
  s_mov_b32 s55, 352384
  buffer_load_dwordx4 v8, s[36:39], s55 offen lds
  buffer_load_dwordx4 v9, s[36:39], s55 offen offset:1024 lds
  s_add_u32 m0, s54, 65536
  s_mov_b32 s55, 352512
  buffer_load_dwordx4 v8, s[36:39], s55 offen lds
  buffer_load_dwordx4 v9, s[36:39], s55 offen offset:1024 lds
  s_add_u32 m0, s54, 73728
  s_mov_b32 s55, 528384
  buffer_load_dwordx4 v8, s[36:39], s55 offen lds
  buffer_load_dwordx4 v9, s[36:39], s55 offen offset:1024 lds
  s_add_u32 m0, s54, 81920
  s_mov_b32 s55, 528512
  buffer_load_dwordx4 v8, s[36:39], s55 offen lds
  buffer_load_dwordx4 v9, s[36:39], s55 offen offset:1024 lds
  s_add_u32 m0, s54, 90112
  s_mov_b32 s55, 528640
  buffer_load_dwordx4 v8, s[36:39], s55 offen lds
  buffer_load_dwordx4 v9, s[36:39], s55 offen offset:1024 lds
kb2_kernel_d2:
  s_waitcnt vmcnt(12) lgkmcnt(0)
  s_barrier
  s_cmp_lt_u32 s7, 8
  s_cbranch_scc1 kb2_kernel_d3
  s_add_u32 m0, s54, 0
  s_mov_b32 s55, 704512
  buffer_load_dwordx4 v8, s[36:39], s55 offen lds
  buffer_load_dwordx4 v9, s[36:39], s55 offen offset:1024 lds
  s_add_u32 m0, s54, 8192
  s_mov_b32 s55, 704640
  buffer_load_dwordx4 v8, s[36:39], s55 offen lds
  buffer_load_dwordx4 v9, s[36:39], s55 offen offset:1024 lds
  s_add_u32 m0, s54, 16384
  s_mov_b32 s55, 704768
  buffer_load_dwordx4 v8, s[36:39], s55 offen lds
  buffer_load_dwordx4 v9, s[36:39], s55 offen offset:1024 lds
kb2_kernel_d3:
  v_mfma_f32_32x32x16_bf16 v[112:127], v[16:19], v[32:35], 0
  ds_read_b64_tr_b16 v[48:49], v11 offset:24576
  ds_read_b64_tr_b16 v[50:51], v11 offset:25088
  ds_read_b128 v[64:67], v12 offset:8192
  v_mfma_f32_32x32x16_bf16 v[112:127], v[20:23], v[36:39], v[112:127]
  ds_read_b64_tr_b16 v[52:53], v11 offset:26624
  ds_read_b64_tr_b16 v[54:55], v11 offset:27136
  ds_read_b128 v[68:71], v13 offset:8192
  v_mfma_f32_32x32x16_bf16 v[112:127], v[24:27], v[40:43], v[112:127]
  ds_read_b64_tr_b16 v[56:57], v11 offset:28672
  ds_read_b64_tr_b16 v[58:59], v11 offset:29184
  ds_read_b128 v[72:75], v14 offset:8192
  v_mfma_f32_32x32x16_bf16 v[112:127], v[28:31], v[44:47], v[112:127]
  ds_read_b64_tr_b16 v[60:61], v11 offset:30720
  ds_read_b64_tr_b16 v[62:63], v11 offset:31232
  ds_read_b128 v[76:79], v15 offset:8192
  s_waitcnt vmcnt(12) lgkmcnt(0)
  s_barrier
  s_cmp_lt_u32 s7, 8
  s_cbranch_scc1 kb2_kernel_d4
  s_add_u32 m0, s54, 24576
  s_mov_b32 s55, 880640
  buffer_load_dwordx4 v8, s[36:39], s55 offen lds
  buffer_load_dwordx4 v9, s[36:39], s55 offen offset:1024 lds
  s_add_u32 m0, s54, 32768
  s_mov_b32 s55, 880768
  buffer_load_dwordx4 v8, s[36:39], s55 offen lds
  buffer_load_dwordx4 v9, s[36:39], s55 offen offset:1024 lds
  s_add_u32 m0, s54, 40960
  s_mov_b32 s55, 880896
  buffer_load_dwordx4 v8, s[36:39], s55 offen lds
  buffer_load_dwordx4 v9, s[36:39], s55 offen offset:1024 lds
kb2_kernel_d4:
  v_mfma_f32_32x32x16_bf16 v[112:127], v[48:51], v[64:67], v[112:127]
  ds_read_b64_tr_b16 v[16:17], v10 offset:0
  ds_read_b64_tr_b16 v[18:19], v10 offset:512
  ds_read_b128 v[32:35], v12 offset:16384
  v_mfma_f32_32x32x16_bf16 v[112:127], v[52:55], v[68:71], v[112:127]
  ds_read_b64_tr_b16 v[20:21], v10 offset:2048
  ds_read_b64_tr_b16 v[22:23], v10 offset:2560
  ds_read_b128 v[36:39], v13 offset:16384
  v_mfma_f32_32x32x16_bf16 v[112:127], v[56:59], v[72:75], v[112:127]
  ds_read_b64_tr_b16 v[24:25], v10 offset:4096
  ds_read_b64_tr_b16 v[26:27], v10 offset:4608
  ds_read_b128 v[40:43], v14 offset:16384
  v_mfma_f32_32x32x16_bf16 v[112:127], v[60:63], v[76:79], v[112:127]
  ds_read_b64_tr_b16 v[28:29], v10 offset:6144
  ds_read_b64_tr_b16 v[30:31], v10 offset:6656
  ds_read_b128 v[44:47], v15 offset:16384
  s_waitcnt vmcnt(12) lgkmcnt(0)
  s_barrier
  s_cmp_lt_u32 s7, 8
  s_cbranch_scc1 kb2_kernel_d5
  s_add_u32 m0, s54, 49152
  s_mov_b32 s55, 1056768
  buffer_load_dwordx4 v8, s[36:39], s55 offen lds
  buffer_load_dwordx4 v9, s[36:39], s55 offen offset:1024 lds
  s_add_u32 m0, s54, 57344
  s_mov_b32 s55, 1056896
  buffer_load_dwordx4 v8, s[36:39], s55 offen lds
  buffer_load_dwordx4 v9, s[36:39], s55 offen offset:1024 lds
  s_add_u32 m0, s54, 65536
  s_mov_b32 s55, 1057024
  buffer_load_dwordx4 v8, s[36:39], s55 offen lds
  buffer_load_dwordx4 v9, s[36:39], s55 offen offset:1024 lds
kb2_kernel_d5:
  v_mfma_f32_32x32x16_bf16 v[112:127], v[16:19], v[32:35], v[112:127]
  ds_read_b64_tr_b16 v[48:49], v10 offset:24576
  ds_read_b64_tr_b16 v[50:51], v10 offset:25088
  ds_read_b128 v[64:67], v12 offset:24576
  v_mfma_f32_32x32x16_bf16 v[112:127], v[20:23], v[36:39], v[112:127]
  ds_read_b64_tr_b16 v[52:53], v10 offset:26624
  ds_read_b64_tr_b16 v[54:55], v10 offset:27136
  ds_read_b128 v[68:71], v13 offset:24576
  v_mfma_f32_32x32x16_bf16 v[112:127], v[24:27], v[40:43], v[112:127]
  ds_read_b64_tr_b16 v[56:57], v10 offset:28672
  ds_read_b64_tr_b16 v[58:59], v10 offset:29184
  ds_read_b128 v[72:75], v14 offset:24576
  v_mfma_f32_32x32x16_bf16 v[112:127], v[28:31], v[44:47], v[112:127]
  ds_read_b64_tr_b16 v[60:61], v10 offset:30720
  ds_read_b64_tr_b16 v[62:63], v10 offset:31232
  ds_read_b128 v[76:79], v15 offset:24576
  s_waitcnt vmcnt(12) lgkmcnt(0)
  s_barrier
  s_cmp_lt_u32 s7, 8
  s_cbranch_scc1 kb2_kernel_d6
  s_add_u32 m0, s54, 73728
  s_mov_b32 s55, 1232896
  buffer_load_dwordx4 v8, s[36:39], s55 offen lds
  buffer_load_dwordx4 v9, s[36:39], s55 offen offset:1024 lds
  s_add_u32 m0, s54, 81920
  s_mov_b32 s55, 1233024
  buffer_load_dwordx4 v8, s[36:39], s55 offen lds
  buffer_load_dwordx4 v9, s[36:39], s55 offen offset:1024 lds
  s_add_u32 m0, s54, 90112
  s_mov_b32 s55, 1233152
  buffer_load_dwordx4 v8, s[36:39], s55 offen lds
  buffer_load_dwordx4 v9, s[36:39], s55 offen offset:1024 lds
kb2_kernel_d6:
  v_mfma_f32_32x32x16_bf16 v[112:127], v[48:51], v[64:67], v[112:127]
  ds_read_b64_tr_b16 v[16:17], v11 offset:0
  ds_read_b64_tr_b16 v[18:19], v11 offset:512
  ds_read_b128 v[32:35], v12 offset:32768
  v_mfma_f32_32x32x16_bf16 v[112:127], v[52:55], v[68:71], v[112:127]
  ds_read_b64_tr_b16 v[20:21], v11 offset:2048
  ds_read_b64_tr_b16 v[22:23], v11 offset:2560
  ds_read_b128 v[36:39], v13 offset:32768
  v_mfma_f32_32x32x16_bf16 v[112:127], v[56:59], v[72:75], v[112:127]
  ds_read_b64_tr_b16 v[24:25], v11 offset:4096
  ds_read_b64_tr_b16 v[26:27], v11 offset:4608
  ds_read_b128 v[40:43], v14 offset:32768
  v_mfma_f32_32x32x16_bf16 v[112:127], v[60:63], v[76:79], v[112:127]
  ds_read_b64_tr_b16 v[28:29], v11 offset:6144
  ds_read_b64_tr_b16 v[30:31], v11 offset:6656
  ds_read_b128 v[44:47], v15 offset:32768
  s_waitcnt vmcnt(12) lgkmcnt(0)
  s_barrier
  v_mfma_f32_32x32x16_bf16 v[112:127], v[16:19], v[32:35], v[112:127]
  ds_read_b64_tr_b16 v[48:49], v11 offset:24576
  ds_read_b64_tr_b16 v[50:51], v11 offset:25088
  ds_read_b128 v[64:67], v12 offset:40960
  v_mfma_f32_32x32x16_bf16 v[112:127], v[20:23], v[36:39], v[112:127]
  ds_read_b64_tr_b16 v[52:53], v11 offset:26624
  ds_read_b64_tr_b16 v[54:55], v11 offset:27136
  ds_read_b128 v[68:71], v13 offset:40960
  v_mfma_f32_32x32x16_bf16 v[112:127], v[24:27], v[40:43], v[112:127]
  ds_read_b64_tr_b16 v[56:57], v11 offset:28672
  ds_read_b64_tr_b16 v[58:59], v11 offset:29184
  ds_read_b128 v[72:75], v14 offset:40960
  v_mfma_f32_32x32x16_bf16 v[112:127], v[28:31], v[44:47], v[112:127]
  ds_read_b64_tr_b16 v[60:61], v11 offset:30720
  ds_read_b64_tr_b16 v[62:63], v11 offset:31232
  ds_read_b128 v[76:79], v15 offset:40960
  s_waitcnt vmcnt(6) lgkmcnt(0)
  s_barrier
  v_mfma_f32_32x32x16_bf16 v[112:127], v[48:51], v[64:67], v[112:127]
  ds_read_b64_tr_b16 v[16:17], v10 offset:0
  ds_read_b64_tr_b16 v[18:19], v10 offset:512
  ds_read_b128 v[32:35], v12 offset:49152
  v_mfma_f32_32x32x16_bf16 v[112:127], v[52:55], v[68:71], v[112:127]
  ds_read_b64_tr_b16 v[20:21], v10 offset:2048
  ds_read_b64_tr_b16 v[22:23], v10 offset:2560
  ds_read_b128 v[36:39], v13 offset:49152
  v_mfma_f32_32x32x16_bf16 v[112:127], v[56:59], v[72:75], v[112:127]
  ds_read_b64_tr_b16 v[24:25], v10 offset:4096
  ds_read_b64_tr_b16 v[26:27], v10 offset:4608
  ds_read_b128 v[40:43], v14 offset:49152
  v_mfma_f32_32x32x16_bf16 v[112:127], v[60:63], v[76:79], v[112:127]
  ds_read_b64_tr_b16 v[28:29], v10 offset:6144
  ds_read_b64_tr_b16 v[30:31], v10 offset:6656
  ds_read_b128 v[44:47], v15 offset:49152
  s_waitcnt vmcnt(0) lgkmcnt(0)
  s_barrier
  v_mfma_f32_32x32x16_bf16 v[112:127], v[16:19], v[32:35], v[112:127]
  ds_read_b64_tr_b16 v[48:49], v10 offset:24576
  ds_read_b64_tr_b16 v[50:51], v10 offset:25088
  ds_read_b128 v[64:67], v12 offset:57344
  v_mfma_f32_32x32x16_bf16 v[112:127], v[20:23], v[36:39], v[112:127]
  ds_read_b64_tr_b16 v[52:53], v10 offset:26624
  ds_read_b64_tr_b16 v[54:55], v10 offset:27136
  ds_read_b128 v[68:71], v13 offset:57344
  v_mfma_f32_32x32x16_bf16 v[112:127], v[24:27], v[40:43], v[112:127]
  ds_read_b64_tr_b16 v[56:57], v10 offset:28672
  ds_read_b64_tr_b16 v[58:59], v10 offset:29184
  ds_read_b128 v[72:75], v14 offset:57344
  v_mfma_f32_32x32x16_bf16 v[112:127], v[28:31], v[44:47], v[112:127]
  ds_read_b64_tr_b16 v[60:61], v10 offset:30720
  ds_read_b64_tr_b16 v[62:63], v10 offset:31232
  ds_read_b128 v[76:79], v15 offset:57344
  s_waitcnt lgkmcnt(9)
  v_mfma_f32_32x32x16_bf16 v[112:127], v[48:51], v[64:67], v[112:127]
  s_waitcnt lgkmcnt(6)
  v_mfma_f32_32x32x16_bf16 v[112:127], v[52:55], v[68:71], v[112:127]
  s_waitcnt lgkmcnt(3)
  v_mfma_f32_32x32x16_bf16 v[112:127], v[56:59], v[72:75], v[112:127]
  s_waitcnt lgkmcnt(0)
  v_mfma_f32_32x32x16_bf16 v[112:127], v[60:63], v[76:79], v[112:127]
  s_mov_b32 s60, 0xbdd2d3e8
  s_mov_b32 s61, s60
  s_mov_b32 s62, 1.0
  s_mov_b32 s63, 1.0
  v_mov_b32 v8, 0xc0135761
  v_mov_b32 v9, 0xc0135761
  s_and_b32 s57, s6, 3
  s_mul_i32 s57, s57, 6
  s_add_u32 s57, s57, s48
  s_lshl_b32 s58, s5, 1
  s_add_u32 s58, s58, s49
  s_nop 7
  s_nop 1
  v_pk_mul_f32 v[16:17], v[112:113], v[112:113]
  v_pk_mul_f32 v[18:19], v[114:115], v[114:115]
  v_pk_mul_f32 v[20:21], v[116:117], v[116:117]
  v_pk_mul_f32 v[22:23], v[118:119], v[118:119]
  v_pk_mul_f32 v[24:25], v[120:121], v[120:121]
  v_pk_mul_f32 v[26:27], v[122:123], v[122:123]
  v_pk_mul_f32 v[28:29], v[124:125], v[124:125]
  v_pk_mul_f32 v[30:31], v[126:127], v[126:127]
  v_pk_fma_f32 v[16:17], v[16:17], s[60:61], v[8:9]
  v_pk_fma_f32 v[18:19], v[18:19], s[60:61], v[8:9]
  v_pk_fma_f32 v[20:21], v[20:21], s[60:61], v[8:9]
  v_pk_fma_f32 v[22:23], v[22:23], s[60:61], v[8:9]
  v_pk_fma_f32 v[24:25], v[24:25], s[60:61], v[8:9]
  v_pk_fma_f32 v[26:27], v[26:27], s[60:61], v[8:9]
  v_pk_fma_f32 v[28:29], v[28:29], s[60:61], v[8:9]
  v_pk_fma_f32 v[30:31], v[30:31], s[60:61], v[8:9]
  v_pk_mul_f32 v[16:17], v[16:17], v[112:113]
  v_pk_mul_f32 v[18:19], v[18:19], v[114:115]
  v_pk_mul_f32 v[20:21], v[20:21], v[116:117]
  v_pk_mul_f32 v[22:23], v[22:23], v[118:119]
  v_pk_mul_f32 v[24:25], v[24:25], v[120:121]
  v_pk_mul_f32 v[26:27], v[26:27], v[122:123]
  v_pk_mul_f32 v[28:29], v[28:29], v[124:125]
  v_pk_mul_f32 v[30:31], v[30:31], v[126:127]
  v_exp_f32 v16, v16
  v_exp_f32 v17, v17
  v_exp_f32 v18, v18
  v_exp_f32 v19, v19
  v_exp_f32 v20, v20
  v_exp_f32 v21, v21
  v_exp_f32 v22, v22
  v_exp_f32 v23, v23
  v_exp_f32 v24, v24
  v_exp_f32 v25, v25
  v_exp_f32 v26, v26
  v_exp_f32 v27, v27
  v_exp_f32 v28, v28
  v_exp_f32 v29, v29
  v_exp_f32 v30, v30
  v_exp_f32 v31, v31
  v_pk_add_f32 v[16:17], v[16:17], s[62:63]
  v_pk_add_f32 v[18:19], v[18:19], s[62:63]
  v_pk_add_f32 v[20:21], v[20:21], s[62:63]
  v_pk_add_f32 v[22:23], v[22:23], s[62:63]
  v_pk_add_f32 v[24:25], v[24:25], s[62:63]
  v_pk_add_f32 v[26:27], v[26:27], s[62:63]
  v_pk_add_f32 v[28:29], v[28:29], s[62:63]
  v_pk_add_f32 v[30:31], v[30:31], s[62:63]
  v_rcp_f32 v16, v16
  v_rcp_f32 v17, v17
  v_rcp_f32 v18, v18
  v_rcp_f32 v19, v19
  v_rcp_f32 v20, v20
  v_rcp_f32 v21, v21
  v_rcp_f32 v22, v22
  v_rcp_f32 v23, v23
  v_rcp_f32 v24, v24
  v_rcp_f32 v25, v25
  v_rcp_f32 v26, v26
  v_rcp_f32 v27, v27
  v_rcp_f32 v28, v28
  v_rcp_f32 v29, v29
  v_rcp_f32 v30, v30
  v_rcp_f32 v31, v31
  v_pk_mul_f32 v[112:113], v[16:17], v[112:113]
  v_pk_mul_f32 v[114:115], v[18:19], v[114:115]
  v_pk_mul_f32 v[116:117], v[20:21], v[116:117]
  v_pk_mul_f32 v[118:119], v[22:23], v[118:119]
  v_pk_mul_f32 v[120:121], v[24:25], v[120:121]
  v_pk_mul_f32 v[122:123], v[26:27], v[122:123]
  v_pk_mul_f32 v[124:125], v[28:29], v[124:125]
  v_pk_mul_f32 v[126:127], v[30:31], v[126:127]
  s_cmp_ge_u32 s6, 4
  s_cbranch_scc1 kb2_kernel_z2
  s_mov_b32 s44, s20
  s_mov_b32 s45, s21
  s_mov_b32 s46, 8388608
  s_mov_b32 s47, 0x00020000
  s_sub_u32 s68, s7, 0
  s_cmp_ge_u32 s68, 8
  s_cbranch_scc1 pf6
  s_lshl_b32 s68, s68, 12
  v_lshlrev_b32 v140, 6, v2
  v_add_u32 v140, s68, v140
  s_lshl_b32 s69, s5, 18
  s_lshl_b32 s68, s6, 16
  s_add_u32 s69, s69, s68
  buffer_load_dword v141, v140, s[44:47], s69 offen
  s_add_u32 s69, s69, 32768
  buffer_load_dword v142, v140, s[44:47], s69 offen
pf6:
  v_cvt_pk_bf16_f32 v16, v112, v113
  v_cvt_pk_bf16_f32 v17, v114, v115
  v_cvt_pk_bf16_f32 v18, v116, v117
  v_cvt_pk_bf16_f32 v19, v118, v119
  v_cvt_pk_bf16_f32 v20, v120, v121
  v_cvt_pk_bf16_f32 v21, v122, v123
  v_cvt_pk_bf16_f32 v22, v124, v125
  v_cvt_pk_bf16_f32 v23, v126, v127
  s_mul_i32 s56, s58, 24
  s_add_u32 s56, s56, s57
  s_lshl_b32 s56, s56, 11
  s_add_u32 s56, s56, 8388608
  v_lshlrev_b32 v7, 4, v2
  buffer_store_dwordx4 v[16:19], v7, s[40:43], s56 offen
  buffer_store_dwordx4 v[20:23], v7, s[40:43], s56 offen offset:1024
  s_endpgm
kb2_kernel_z2:
  s_cmp_lt_u32 s57, 21
  s_cbranch_scc1 kb2_kernel_nm
  v_mov_b32 v120, 0
  v_mov_b32 v121, 0
  v_mov_b32 v122, 0
  v_mov_b32 v123, 0
  v_mov_b32 v124, 0
  v_mov_b32 v125, 0
  v_mov_b32 v126, 0
  v_mov_b32 v127, 0
  s_cmp_lt_u32 s57, 22
  s_cbranch_scc1 kb2_kernel_nm
  v_mov_b32 v112, 0
  v_mov_b32 v113, 0
  v_mov_b32 v114, 0
  v_mov_b32 v115, 0
  v_mov_b32 v116, 0
  v_mov_b32 v117, 0
  v_mov_b32 v118, 0
  v_mov_b32 v119, 0
kb2_kernel_nm:
  v_pk_add_f32 v[16:17], v[112:113], v[114:115]
  v_pk_mul_f32 v[18:19], v[112:113], v[112:113]
  v_pk_fma_f32 v[18:19], v[114:115], v[114:115], v[18:19]
  v_pk_add_f32 v[16:17], v[16:17], v[116:117]
  v_pk_fma_f32 v[18:19], v[116:117], v[116:117], v[18:19]
  v_pk_add_f32 v[16:17], v[16:17], v[118:119]
  v_pk_fma_f32 v[18:19], v[118:119], v[118:119], v[18:19]
  v_pk_add_f32 v[16:17], v[16:17], v[120:121]
  v_pk_fma_f32 v[18:19], v[120:121], v[120:121], v[18:19]
  v_pk_add_f32 v[16:17], v[16:17], v[122:123]
  v_pk_fma_f32 v[18:19], v[122:123], v[122:123], v[18:19]
  v_pk_add_f32 v[16:17], v[16:17], v[124:125]
  v_pk_fma_f32 v[18:19], v[124:125], v[124:125], v[18:19]
  v_pk_add_f32 v[16:17], v[16:17], v[126:127]
  v_pk_fma_f32 v[18:19], v[126:127], v[126:127], v[18:19]
  v_add_f32 v16, v16, v17
  v_add_f32 v17, v18, v19
  v_mov_b32 v18, v16
  s_nop 1
  v_permlane32_swap_b32 v16, v18
  s_nop 1
  v_add_f32 v16, v16, v18
  v_mov_b32 v19, v17
  s_nop 1
  v_permlane32_swap_b32 v17, v19
  s_nop 1
  v_add_f32 v17, v17, v19
  s_lshl_b32 s56, s49, 5
  v_add_u32 v6, s56, v3
  v_lshlrev_b32 v6, 3, v6
  s_lshl_b32 s56, s48, 9
  v_add_u32 v7, s56, v6
  ds_write_b64 v7, v[16:17]
  s_waitcnt lgkmcnt(0)
  s_barrier
  s_cmp_lg_u32 s7, 0
  s_cbranch_scc1 kb2_kernel_w
  v_lshlrev_b32 v7, 3, v2
  ds_read_b64 v[16:17], v7 offset:0
  ds_read_b64 v[18:19], v7 offset:512
  ds_read_b64 v[20:21], v7 offset:1024
  ds_read_b64 v[22:23], v7 offset:1536
  ds_read_b64 v[24:25], v7 offset:2048
  ds_read_b64 v[26:27], v7 offset:2560
  s_lshl_b32 s56, s5, 11
  s_add_u32 s56, s56, 20971520
  s_and_b32 s59, s6, 3
  s_lshl_b32 s59, s59, 9
  s_add_u32 s59, s59, s56
  s_waitcnt lgkmcnt(0)
  v_pk_add_f32 v[16:17], v[16:17], v[18:19]
  v_pk_add_f32 v[16:17], v[16:17], v[20:21]
  v_pk_add_f32 v[16:17], v[16:17], v[22:23]
  v_pk_add_f32 v[16:17], v[16:17], v[24:25]
  v_pk_add_f32 v[16:17], v[16:17], v[26:27]
  buffer_store_dwordx2 v[16:17], v7, s[40:43], s59 offen sc0 sc1
  s_mov_b32 s59, 0
kb2_kernel_poll:
  buffer_load_dwordx2 v[20:21], v7, s[40:43], s56 offen offset:0 sc0 sc1
  buffer_load_dwordx2 v[22:23], v7, s[40:43], s56 offen offset:512 sc0 sc1
  buffer_load_dwordx2 v[24:25], v7, s[40:43], s56 offen offset:1024 sc0 sc1
  buffer_load_dwordx2 v[26:27], v7, s[40:43], s56 offen offset:1536 sc0 sc1
  s_add_u32 s59, s59, 1
  s_waitcnt vmcnt(0)
  v_max_u32 v18, v21, v23
  v_max3_u32 v18, v18, v25, v27
  v_cmp_eq_u32 vcc, -1, v18
  s_cmp_gt_u32 s59, 0x4000
  s_cbranch_scc1 kb2_kernel_go
  s_nop 1
  s_cbranch_vccnz kb2_kernel_poll
kb2_kernel_go:
  v_pk_add_f32 v[20:21], v[20:21], v[22:23]
  v_pk_add_f32 v[24:25], v[24:25], v[26:27]
  v_pk_add_f32 v[20:21], v[20:21], v[24:25]
  v_mul_f32 v20, 0x3abe82fa, v20
  v_mul_f32 v21, 0x3abe82fa, v21
  v_fma_f32 v21, -v20, v20, v21
  v_max_f32 v21, 0, v21
  v_add_f32 v21, 0x3727c5ac, v21
  v_rsq_f32 v21, v21
  s_nop 0
  v_mul_f32 v20, v20, v21
  v_mul_f32 v20, -1.0, v20
  ds_write_b64 v7, v[20:21] offset:4096
  s_waitcnt lgkmcnt(0)
kb2_kernel_w:
  s_barrier
  ds_read_b64 v[16:17], v6 offset:4096
  s_mul_i32 s56, s7, 2560
  s_add_u32 s56, s56, 8192
  v_mul_u32_u24 v7, 80, v3
  v_lshl_add_u32 v7, v4, 3, v7
  v_add_u32 v7, s56, v7
  v_bfe_u32 v8, v2, 2, 2
  v_mad_u32_u24 v10, v4, 8, v8
  v_mul_u32_u24 v10, 80, v10
  v_bfe_u32 v9, v2, 4, 1
  v_lshlrev_b32 v9, 5, v9
  v_and_b32 v8, 3, v2
  v_lshl_add_u32 v9, v8, 3, v9
  v_add_u32 v9, s56, v9
  v_add_u32 v10, v10, v9
  s_mul_i32 s56, s5, 98304
  s_lshl_b32 s59, s57, 12
  s_add_u32 s56, s56, s59
  s_add_u32 s56, s56, 12582912
  s_lshl_b32 s59, s49, 2
  v_bfe_u32 v8, v3, 1, 3
  v_xor_b32 v8, v8, v4
  v_xor_b32 v8, s59, v8
  v_xor_b32 v9, 2, v8
  v_lshlrev_b32 v11, 7, v3
  v_lshl_add_u32 v8, v8, 4, v11
  v_lshl_add_u32 v9, v9, 4, v11
  s_waitcnt lgkmcnt(0)
  v_fma_f32 v112, v112, v17, v16
  v_fma_f32 v113, v113, v17, v16
  v_fma_f32 v114, v114, v17, v16
  v_fma_f32 v115, v115, v17, v16
  v_fma_f32 v116, v116, v17, v16
  v_fma_f32 v117, v117, v17, v16
  v_fma_f32 v118, v118, v17, v16
  v_fma_f32 v119, v119, v17, v16
  v_fma_f32 v120, v120, v17, v16
  v_fma_f32 v121, v121, v17, v16
  v_fma_f32 v122, v122, v17, v16
  v_fma_f32 v123, v123, v17, v16
  v_fma_f32 v124, v124, v17, v16
  v_fma_f32 v125, v125, v17, v16
  v_fma_f32 v126, v126, v17, v16
  v_fma_f32 v127, v127, v17, v16
  v_cvt_pk_bf16_f32 v20, v112, v113
  v_cvt_pk_bf16_f32 v21, v114, v115
  v_cvt_pk_bf16_f32 v22, v116, v117
  v_cvt_pk_bf16_f32 v23, v118, v119
  v_cvt_pk_bf16_f32 v24, v120, v121
  v_cvt_pk_bf16_f32 v25, v122, v123
  v_cvt_pk_bf16_f32 v26, v124, v125
  v_cvt_pk_bf16_f32 v27, v126, v127
  ds_write_b64 v7, v[20:21] offset:0
  ds_write_b64 v7, v[22:23] offset:16
  ds_write_b64 v7, v[24:25] offset:32
  ds_write_b64 v7, v[26:27] offset:48
  s_waitcnt lgkmcnt(0)
  ds_read_b64_tr_b16 v[32:33], v10 offset:0
  ds_read_b64_tr_b16 v[34:35], v10 offset:320
  ds_read_b64_tr_b16 v[36:37], v10 offset:1280
  ds_read_b64_tr_b16 v[38:39], v10 offset:1600
  s_waitcnt lgkmcnt(0)
  buffer_store_dwordx4 v[32:35], v8, s[40:43], s56 offen
  buffer_store_dwordx4 v[36:39], v9, s[40:43], s56 offen
kb2_kernel_end:
  s_endpgm
.globl kc1_kernel
.p2align 8
.type kc1_kernel,@function
kc1_kernel:
  s_cmp_ge_u32 s2, 256
  s_cbranch_scc1 kc1_kernel_end
  s_load_dwordx16 s[8:23], s[0:1], 0
  s_load_dwordx8 s[24:31], s[0:1], 64
  s_and_b32 s3, s2, 7
  s_lshr_b32 s4, s2, 3
  s_lshl_b32 s5, s3, 2
  s_lshr_b32 s6, s4, 3
  s_add_u32 s5, s5, s6
  s_and_b32 s6, s4, 7
  v_lshrrev_b32 v1, 6, v0
  v_and_b32 v2, 63, v0
  v_readfirstlane_b32 s7, v1
  v_and_b32 v3, 31, v0
  v_bfe_u32 v4, v0, 5, 1
  s_waitcnt lgkmcnt(0)
  s_mov_b32 s32, s22
  s_mov_b32 s33, s23
  s_mov_b32 s34, 4096
  s_mov_b32 s35, 0x00020000
  s_mov_b32 s36, s20
  s_mov_b32 s37, s21
  s_mov_b32 s38, 8388608
  s_mov_b32 s39, 0x00020000
  s_mov_b32 s40, s30
  s_mov_b32 s41, s31
  s_mov_b32 s42, 268435456
  s_mov_b32 s43, 0x00020000
  s_and_b32 s49, s7, 1
  s_lshr_b32 s48, s7, 1
  s_lshr_b32 s50, s7, 2
  s_and_b32 s51, s7, 3
  s_mul_i32 s52, s50, 20480
  s_mul_i32 s53, s51, 3072
  s_add_u32 s54, s52, s53
  s_lshl_b32 s55, s51, 11
  s_add_u32 s55, s55, s52
  s_add_u32 s55, s55, 12288
  s_mul_i32 s56, s50, 98304
  s_mul_i32 s57, s6, 12288
  s_add_u32 s56, s56, s57
  s_add_u32 s56, s56, s53
  s_add_u32 s56, s56, 12582912
  v_lshlrev_b32 v5, 4, v2
  s_lshl_b32 s57, s5, 18
  s_lshl_b32 s58, s51, 16
  s_add_u32 s57, s57, s58
  s_lshl_b32 s58, s50, 7
  s_add_u32 s57, s57, s58
  v_lshrrev_b32 v6, 3, v2
  v_lshlrev_b32 v6, 12, v6
  v_lshrrev_b32 v7, 4, v2
  v_and_b32 v8, 7, v2
  v_xor_b32 v7, v7, v8
  v_xor_b32 v8, 4, v7
  v_lshl_add_u32 v7, v7, 4, v6
  v_lshl_add_u32 v8, v8, 4, v6
  v_add_u32 v8, 31744, v8
  s_lshl_b32 s59, s5, 7
  s_lshl_b32 s60, s50, 6
  s_add_u32 s59, s59, s60
  v_lshlrev_b32 v10, 1, v3
  buffer_load_ushort v9, v10, s[32:35], s59 offen
  s_lshl_b32 s59, s5, 1
  s_add_u32 s59, s59, s50
  s_mul_i32 s59, s59, 48
  s_mul_i32 s60, s6, 6
  s_add_u32 s59, s59, s60
  s_lshl_b32 s59, s59, 10
  s_mul_i32 s60, s51, 3
  s_add_u32 s61, s60, 0
  s_lshr_b32 s62, s61, 1
  s_lshl_b32 s62, s62, 10
  s_and_b32 s61, s61, 1
  s_lshl_b32 s61, s61, 3
  s_add_u32 s62, s62, s61
  s_add_u32 s64, s62, s59
  s_add_u32 s62, s64, 8388608
  s_add_u32 s64, s64, 16777216
  buffer_load_dwordx2 v[128:129], v5, s[40:43], s62 offen
  s_add_u32 s61, s60, 1
  s_lshr_b32 s62, s61, 1
  s_lshl_b32 s62, s62, 10
  s_and_b32 s61, s61, 1
  s_lshl_b32 s61, s61, 3
  s_add_u32 s62, s62, s61
  s_add_u32 s65, s62, s59
  s_add_u32 s62, s65, 8388608
  s_add_u32 s65, s65, 16777216
  buffer_load_dwordx2 v[130:131], v5, s[40:43], s62 offen
  s_add_u32 s61, s60, 2
  s_lshr_b32 s62, s61, 1
  s_lshl_b32 s62, s62, 10
  s_and_b32 s61, s61, 1
  s_lshl_b32 s61, s61, 3
  s_add_u32 s62, s62, s61
  s_add_u32 s66, s62, s59
  s_add_u32 s62, s66, 8388608
  s_add_u32 s66, s66, 16777216
  buffer_load_dwordx2 v[132:133], v5, s[40:43], s62 offen
  s_add_u32 m0, s54, 0
  s_add_u32 s58, s56, 0
  buffer_load_dwordx4 v5, s[40:43], s58 offen offset:0 lds
  buffer_load_dwordx4 v5, s[40:43], s58 offen offset:1024 lds
  buffer_load_dwordx4 v5, s[40:43], s58 offen offset:2048 lds
  s_add_u32 m0, s55, 0
  s_add_u32 s58, s57, 0
  buffer_load_dwordx4 v7, s[36:39], s58 offen lds
  buffer_load_dwordx4 v8, s[36:39], s58 offen offset:1024 lds
  s_add_u32 m0, s54, 40960
  s_add_u32 s58, s56, 196608
  buffer_load_dwordx4 v5, s[40:43], s58 offen offset:0 lds
  buffer_load_dwordx4 v5, s[40:43], s58 offen offset:1024 lds
  buffer_load_dwordx4 v5, s[40:43], s58 offen offset:2048 lds
  s_add_u32 m0, s55, 40960
  s_add_u32 s58, s57, 256
  buffer_load_dwordx4 v7, s[36:39], s58 offen lds
  buffer_load_dwordx4 v8, s[36:39], s58 offen offset:1024 lds
  s_lshl_b32 s59, s48, 1
  v_bfe_u32 v10, v3, 1, 3
  v_xor_b32 v10, v10, v4
  v_xor_b32 v10, s59, v10
  v_lshlrev_b32 v10, 4, v10
  v_lshl_add_u32 v10, v3, 7, v10
  s_lshl_b32 s59, s49, 12
  s_add_u32 s59, s59, 12288
  v_add_u32 v134, s59, v10
  v_add_u32 v11, 40960, v10
  v_add_u32 v12, 81920, v10
  v_add_u32 v13, 122880, v10
  v_add_u32 v135, 40960, v134
  v_add_u32 v136, 81920, v134
  v_add_u32 v137, 122880, v134
  s_waitcnt vmcnt(5) lgkmcnt(0)
  s_barrier
  ds_read_b128 v[28:31], v134 offset:0
  ds_read_b128 v[16:19], v10 offset:0
  ds_read_b128 v[20:23], v10 offset:4096
  ds_read_b128 v[24:27], v10 offset:8192
  ds_read_b128 v[44:47], v134 offset:20480
  ds_read_b128 v[32:35], v10 offset:20480
  ds_read_b128 v[36:39], v10 offset:24576
  ds_read_b128 v[40:43], v10 offset:28672
  s_add_u32 m0, s54, 81920
  s_add_u32 s58, s56, 393216
  buffer_load_dwordx4 v5, s[40:43], s58 offen offset:0 lds
  buffer_load_dwordx4 v5, s[40:43], s58 offen offset:1024 lds
  buffer_load_dwordx4 v5, s[40:43], s58 offen offset:2048 lds
  s_add_u32 m0, s55, 81920
  s_add_u32 s58, s57, 512
  buffer_load_dwordx4 v7, s[36:39], s58 offen lds
  buffer_load_dwordx4 v8, s[36:39], s58 offen offset:1024 lds
  s_add_u32 m0, s54, 122880
  s_add_u32 s58, s56, 589824
  buffer_load_dwordx4 v5, s[40:43], s58 offen offset:0 lds
  buffer_load_dwordx4 v5, s[40:43], s58 offen offset:1024 lds
  buffer_load_dwordx4 v5, s[40:43], s58 offen offset:2048 lds
  s_add_u32 m0, s55, 122880
  s_add_u32 s58, s57, 768
  buffer_load_dwordx4 v7, s[36:39], s58 offen lds
  buffer_load_dwordx4 v8, s[36:39], s58 offen offset:1024 lds
  s_waitcnt vmcnt(10) lgkmcnt(0)
  s_barrier
  ds_read_b128 v[60:63], v135 offset:0
  ds_read_b128 v[48:51], v11 offset:0
  ds_read_b128 v[52:55], v11 offset:4096
  ds_read_b128 v[56:59], v11 offset:8192
  ds_read_b128 v[76:79], v135 offset:20480
  ds_read_b128 v[64:67], v11 offset:20480
  ds_read_b128 v[68:71], v11 offset:24576
  ds_read_b128 v[72:75], v11 offset:28672
  v_mfma_f32_32x32x16_bf16 v[80:95], v[16:19], v[28:31], 0
  v_mfma_f32_32x32x16_bf16 v[96:111], v[20:23], v[28:31], 0
  v_mfma_f32_32x32x16_bf16 v[112:127], v[24:27], v[28:31], 0
  v_mfma_f32_32x32x16_bf16 v[80:95], v[32:35], v[44:47], v[80:95]
  v_mfma_f32_32x32x16_bf16 v[96:111], v[36:39], v[44:47], v[96:111]
  v_mfma_f32_32x32x16_bf16 v[112:127], v[40:43], v[44:47], v[112:127]
  s_add_u32 m0, s54, 0
  s_add_u32 s58, s56, 786432
  buffer_load_dwordx4 v5, s[40:43], s58 offen offset:0 lds
  buffer_load_dwordx4 v5, s[40:43], s58 offen offset:1024 lds
  buffer_load_dwordx4 v5, s[40:43], s58 offen offset:2048 lds
  s_add_u32 m0, s55, 0
  s_add_u32 s58, s57, 1024
  buffer_load_dwordx4 v7, s[36:39], s58 offen lds
  buffer_load_dwordx4 v8, s[36:39], s58 offen offset:1024 lds
  s_waitcnt vmcnt(10) lgkmcnt(0)
  s_barrier
  ds_read_b128 v[28:31], v136 offset:0
  ds_read_b128 v[16:19], v12 offset:0
  ds_read_b128 v[20:23], v12 offset:4096
  ds_read_b128 v[24:27], v12 offset:8192
  ds_read_b128 v[44:47], v136 offset:20480
  ds_read_b128 v[32:35], v12 offset:20480
  ds_read_b128 v[36:39], v12 offset:24576
  ds_read_b128 v[40:43], v12 offset:28672
  v_mfma_f32_32x32x16_bf16 v[80:95], v[48:51], v[60:63], v[80:95]
  v_mfma_f32_32x32x16_bf16 v[96:111], v[52:55], v[60:63], v[96:111]
  v_mfma_f32_32x32x16_bf16 v[112:127], v[56:59], v[60:63], v[112:127]
  v_mfma_f32_32x32x16_bf16 v[80:95], v[64:67], v[76:79], v[80:95]
  v_mfma_f32_32x32x16_bf16 v[96:111], v[68:71], v[76:79], v[96:111]
  v_mfma_f32_32x32x16_bf16 v[112:127], v[72:75], v[76:79], v[112:127]
  s_add_u32 m0, s54, 40960
  s_add_u32 s58, s56, 983040
  buffer_load_dwordx4 v5, s[40:43], s58 offen offset:0 lds
  buffer_load_dwordx4 v5, s[40:43], s58 offen offset:1024 lds
  buffer_load_dwordx4 v5, s[40:43], s58 offen offset:2048 lds
  s_add_u32 m0, s55, 40960
  s_add_u32 s58, s57, 1280
  buffer_load_dwordx4 v7, s[36:39], s58 offen lds
  buffer_load_dwordx4 v8, s[36:39], s58 offen offset:1024 lds
  s_waitcnt vmcnt(10) lgkmcnt(0)
  s_barrier
  ds_read_b128 v[60:63], v137 offset:0
  ds_read_b128 v[48:51], v13 offset:0
  ds_read_b128 v[52:55], v13 offset:4096
  ds_read_b128 v[56:59], v13 offset:8192
  ds_read_b128 v[76:79], v137 offset:20480
  ds_read_b128 v[64:67], v13 offset:20480
  ds_read_b128 v[68:71], v13 offset:24576
  ds_read_b128 v[72:75], v13 offset:28672
  v_mfma_f32_32x32x16_bf16 v[80:95], v[16:19], v[28:31], v[80:95]
  v_mfma_f32_32x32x16_bf16 v[96:111], v[20:23], v[28:31], v[96:111]
  v_mfma_f32_32x32x16_bf16 v[112:127], v[24:27], v[28:31], v[112:127]
  v_mfma_f32_32x32x16_bf16 v[80:95], v[32:35], v[44:47], v[80:95]
  v_mfma_f32_32x32x16_bf16 v[96:111], v[36:39], v[44:47], v[96:111]
  v_mfma_f32_32x32x16_bf16 v[112:127], v[40:43], v[44:47], v[112:127]
  s_add_u32 m0, s54, 81920
  s_add_u32 s58, s56, 1179648
  buffer_load_dwordx4 v5, s[40:43], s58 offen offset:0 lds
  buffer_load_dwordx4 v5, s[40:43], s58 offen offset:1024 lds
  buffer_load_dwordx4 v5, s[40:43], s58 offen offset:2048 lds
  s_add_u32 m0, s55, 81920
  s_add_u32 s58, s57, 1536
  buffer_load_dwordx4 v7, s[36:39], s58 offen lds
  buffer_load_dwordx4 v8, s[36:39], s58 offen offset:1024 lds
  s_waitcnt vmcnt(10) lgkmcnt(0)
  s_barrier
  ds_read_b128 v[28:31], v134 offset:0
  ds_read_b128 v[16:19], v10 offset:0
  ds_read_b128 v[20:23], v10 offset:4096
  ds_read_b128 v[24:27], v10 offset:8192
  ds_read_b128 v[44:47], v134 offset:20480
  ds_read_b128 v[32:35], v10 offset:20480
  ds_read_b128 v[36:39], v10 offset:24576
  ds_read_b128 v[40:43], v10 offset:28672
  v_mfma_f32_32x32x16_bf16 v[80:95], v[48:51], v[60:63], v[80:95]
  v_mfma_f32_32x32x16_bf16 v[96:111], v[52:55], v[60:63], v[96:111]
  v_mfma_f32_32x32x16_bf16 v[112:127], v[56:59], v[60:63], v[112:127]
  v_mfma_f32_32x32x16_bf16 v[80:95], v[64:67], v[76:79], v[80:95]
  v_mfma_f32_32x32x16_bf16 v[96:111], v[68:71], v[76:79], v[96:111]
  v_mfma_f32_32x32x16_bf16 v[112:127], v[72:75], v[76:79], v[112:127]
  s_add_u32 m0, s54, 122880
  s_add_u32 s58, s56, 1376256
  buffer_load_dwordx4 v5, s[40:43], s58 offen offset:0 lds
  buffer_load_dwordx4 v5, s[40:43], s58 offen offset:1024 lds
  buffer_load_dwordx4 v5, s[40:43], s58 offen offset:2048 lds
  s_add_u32 m0, s55, 122880
  s_add_u32 s58, s57, 1792
  buffer_load_dwordx4 v7, s[36:39], s58 offen lds
  buffer_load_dwordx4 v8, s[36:39], s58 offen offset:1024 lds
  s_waitcnt vmcnt(10) lgkmcnt(0)
  s_barrier
  ds_read_b128 v[60:63], v135 offset:0
  ds_read_b128 v[48:51], v11 offset:0
  ds_read_b128 v[52:55], v11 offset:4096
  ds_read_b128 v[56:59], v11 offset:8192
  ds_read_b128 v[76:79], v135 offset:20480
  ds_read_b128 v[64:67], v11 offset:20480
  ds_read_b128 v[68:71], v11 offset:24576
  ds_read_b128 v[72:75], v11 offset:28672
  v_mfma_f32_32x32x16_bf16 v[80:95], v[16:19], v[28:31], v[80:95]
  v_mfma_f32_32x32x16_bf16 v[96:111], v[20:23], v[28:31], v[96:111]
  v_mfma_f32_32x32x16_bf16 v[112:127], v[24:27], v[28:31], v[112:127]
  v_mfma_f32_32x32x16_bf16 v[80:95], v[32:35], v[44:47], v[80:95]
  v_mfma_f32_32x32x16_bf16 v[96:111], v[36:39], v[44:47], v[96:111]
  v_mfma_f32_32x32x16_bf16 v[112:127], v[40:43], v[44:47], v[112:127]
  s_add_u32 m0, s54, 0
  s_add_u32 s58, s56, 1572864
  buffer_load_dwordx4 v5, s[40:43], s58 offen offset:0 lds
  buffer_load_dwordx4 v5, s[40:43], s58 offen offset:1024 lds
  buffer_load_dwordx4 v5, s[40:43], s58 offen offset:2048 lds
  s_add_u32 m0, s55, 0
  s_add_u32 s58, s57, 2048
  buffer_load_dwordx4 v7, s[36:39], s58 offen lds
  buffer_load_dwordx4 v8, s[36:39], s58 offen offset:1024 lds
  s_waitcnt vmcnt(10) lgkmcnt(0)
  s_barrier
  ds_read_b128 v[28:31], v136 offset:0
  ds_read_b128 v[16:19], v12 offset:0
  ds_read_b128 v[20:23], v12 offset:4096
  ds_read_b128 v[24:27], v12 offset:8192
  ds_read_b128 v[44:47], v136 offset:20480
  ds_read_b128 v[32:35], v12 offset:20480
  ds_read_b128 v[36:39], v12 offset:24576
  ds_read_b128 v[40:43], v12 offset:28672
  v_mfma_f32_32x32x16_bf16 v[80:95], v[48:51], v[60:63], v[80:95]
  v_mfma_f32_32x32x16_bf16 v[96:111], v[52:55], v[60:63], v[96:111]
  v_mfma_f32_32x32x16_bf16 v[112:127], v[56:59], v[60:63], v[112:127]
  v_mfma_f32_32x32x16_bf16 v[80:95], v[64:67], v[76:79], v[80:95]
  v_mfma_f32_32x32x16_bf16 v[96:111], v[68:71], v[76:79], v[96:111]
  v_mfma_f32_32x32x16_bf16 v[112:127], v[72:75], v[76:79], v[112:127]
  s_add_u32 m0, s54, 40960
  s_add_u32 s58, s56, 1769472
  buffer_load_dwordx4 v5, s[40:43], s58 offen offset:0 lds
  buffer_load_dwordx4 v5, s[40:43], s58 offen offset:1024 lds
  buffer_load_dwordx4 v5, s[40:43], s58 offen offset:2048 lds
  s_add_u32 m0, s55, 40960
  s_add_u32 s58, s57, 2304
  buffer_load_dwordx4 v7, s[36:39], s58 offen lds
  buffer_load_dwordx4 v8, s[36:39], s58 offen offset:1024 lds
  s_waitcnt vmcnt(10) lgkmcnt(0)
  s_barrier
  ds_read_b128 v[60:63], v137 offset:0
  ds_read_b128 v[48:51], v13 offset:0
  ds_read_b128 v[52:55], v13 offset:4096
  ds_read_b128 v[56:59], v13 offset:8192
  ds_read_b128 v[76:79], v137 offset:20480
  ds_read_b128 v[64:67], v13 offset:20480
  ds_read_b128 v[68:71], v13 offset:24576
  ds_read_b128 v[72:75], v13 offset:28672
  v_mfma_f32_32x32x16_bf16 v[80:95], v[16:19], v[28:31], v[80:95]
  v_mfma_f32_32x32x16_bf16 v[96:111], v[20:23], v[28:31], v[96:111]
  v_mfma_f32_32x32x16_bf16 v[112:127], v[24:27], v[28:31], v[112:127]
  v_mfma_f32_32x32x16_bf16 v[80:95], v[32:35], v[44:47], v[80:95]
  v_mfma_f32_32x32x16_bf16 v[96:111], v[36:39], v[44:47], v[96:111]
  v_mfma_f32_32x32x16_bf16 v[112:127], v[40:43], v[44:47], v[112:127]
  s_add_u32 m0, s54, 81920
  s_add_u32 s58, s56, 1966080
  buffer_load_dwordx4 v5, s[40:43], s58 offen offset:0 lds
  buffer_load_dwordx4 v5, s[40:43], s58 offen offset:1024 lds
  buffer_load_dwordx4 v5, s[40:43], s58 offen offset:2048 lds
  s_add_u32 m0, s55, 81920
  s_add_u32 s58, s57, 2560
  buffer_load_dwordx4 v7, s[36:39], s58 offen lds
  buffer_load_dwordx4 v8, s[36:39], s58 offen offset:1024 lds
  s_waitcnt vmcnt(10) lgkmcnt(0)
  s_barrier
  ds_read_b128 v[28:31], v134 offset:0
  ds_read_b128 v[16:19], v10 offset:0
  ds_read_b128 v[20:23], v10 offset:4096
  ds_read_b128 v[24:27], v10 offset:8192
  ds_read_b128 v[44:47], v134 offset:20480
  ds_read_b128 v[32:35], v10 offset:20480
  ds_read_b128 v[36:39], v10 offset:24576
  ds_read_b128 v[40:43], v10 offset:28672
  v_mfma_f32_32x32x16_bf16 v[80:95], v[48:51], v[60:63], v[80:95]
  v_mfma_f32_32x32x16_bf16 v[96:111], v[52:55], v[60:63], v[96:111]
  v_mfma_f32_32x32x16_bf16 v[112:127], v[56:59], v[60:63], v[112:127]
  v_mfma_f32_32x32x16_bf16 v[80:95], v[64:67], v[76:79], v[80:95]
  v_mfma_f32_32x32x16_bf16 v[96:111], v[68:71], v[76:79], v[96:111]
  v_mfma_f32_32x32x16_bf16 v[112:127], v[72:75], v[76:79], v[112:127]
  s_add_u32 m0, s54, 122880
  s_add_u32 s58, s56, 2162688
  buffer_load_dwordx4 v5, s[40:43], s58 offen offset:0 lds
  buffer_load_dwordx4 v5, s[40:43], s58 offen offset:1024 lds
  buffer_load_dwordx4 v5, s[40:43], s58 offen offset:2048 lds
  s_add_u32 m0, s55, 122880
  s_add_u32 s58, s57, 2816
  buffer_load_dwordx4 v7, s[36:39], s58 offen lds
  buffer_load_dwordx4 v8, s[36:39], s58 offen offset:1024 lds
  s_waitcnt vmcnt(10) lgkmcnt(0)
  s_barrier
  ds_read_b128 v[60:63], v135 offset:0
  ds_read_b128 v[48:51], v11 offset:0
  ds_read_b128 v[52:55], v11 offset:4096
  ds_read_b128 v[56:59], v11 offset:8192
  ds_read_b128 v[76:79], v135 offset:20480
  ds_read_b128 v[64:67], v11 offset:20480
  ds_read_b128 v[68:71], v11 offset:24576
  ds_read_b128 v[72:75], v11 offset:28672
  v_mfma_f32_32x32x16_bf16 v[80:95], v[16:19], v[28:31], v[80:95]
  v_mfma_f32_32x32x16_bf16 v[96:111], v[20:23], v[28:31], v[96:111]
  v_mfma_f32_32x32x16_bf16 v[112:127], v[24:27], v[28:31], v[112:127]
  v_mfma_f32_32x32x16_bf16 v[80:95], v[32:35], v[44:47], v[80:95]
  v_mfma_f32_32x32x16_bf16 v[96:111], v[36:39], v[44:47], v[96:111]
  v_mfma_f32_32x32x16_bf16 v[112:127], v[40:43], v[44:47], v[112:127]
  s_add_u32 m0, s54, 0
  s_add_u32 s58, s56, 2359296
  buffer_load_dwordx4 v5, s[40:43], s58 offen offset:0 lds
  buffer_load_dwordx4 v5, s[40:43], s58 offen offset:1024 lds
  buffer_load_dwordx4 v5, s[40:43], s58 offen offset:2048 lds
  s_add_u32 m0, s55, 0
  s_add_u32 s58, s57, 3072
  buffer_load_dwordx4 v7, s[36:39], s58 offen lds
  buffer_load_dwordx4 v8, s[36:39], s58 offen offset:1024 lds
  s_waitcnt vmcnt(10) lgkmcnt(0)
  s_barrier
  ds_read_b128 v[28:31], v136 offset:0
  ds_read_b128 v[16:19], v12 offset:0
  ds_read_b128 v[20:23], v12 offset:4096
  ds_read_b128 v[24:27], v12 offset:8192
  ds_read_b128 v[44:47], v136 offset:20480
  ds_read_b128 v[32:35], v12 offset:20480
  ds_read_b128 v[36:39], v12 offset:24576
  ds_read_b128 v[40:43], v12 offset:28672
  v_mfma_f32_32x32x16_bf16 v[80:95], v[48:51], v[60:63], v[80:95]
  v_mfma_f32_32x32x16_bf16 v[96:111], v[52:55], v[60:63], v[96:111]
  v_mfma_f32_32x32x16_bf16 v[112:127], v[56:59], v[60:63], v[112:127]
  v_mfma_f32_32x32x16_bf16 v[80:95], v[64:67], v[76:79], v[80:95]
  v_mfma_f32_32x32x16_bf16 v[96:111], v[68:71], v[76:79], v[96:111]
  v_mfma_f32_32x32x16_bf16 v[112:127], v[72:75], v[76:79], v[112:127]
  s_add_u32 m0, s54, 40960
  s_add_u32 s58, s56, 2555904
  buffer_load_dwordx4 v5, s[40:43], s58 offen offset:0 lds
  buffer_load_dwordx4 v5, s[40:43], s58 offen offset:1024 lds
  buffer_load_dwordx4 v5, s[40:43], s58 offen offset:2048 lds
  s_add_u32 m0, s55, 40960
  s_add_u32 s58, s57, 3328
  buffer_load_dwordx4 v7, s[36:39], s58 offen lds
  buffer_load_dwordx4 v8, s[36:39], s58 offen offset:1024 lds
  s_waitcnt vmcnt(10) lgkmcnt(0)
  s_barrier
  ds_read_b128 v[60:63], v137 offset:0
  ds_read_b128 v[48:51], v13 offset:0
  ds_read_b128 v[52:55], v13 offset:4096
  ds_read_b128 v[56:59], v13 offset:8192
  ds_read_b128 v[76:79], v137 offset:20480
  ds_read_b128 v[64:67], v13 offset:20480
  ds_read_b128 v[68:71], v13 offset:24576
  ds_read_b128 v[72:75], v13 offset:28672
  v_mfma_f32_32x32x16_bf16 v[80:95], v[16:19], v[28:31], v[80:95]
  v_mfma_f32_32x32x16_bf16 v[96:111], v[20:23], v[28:31], v[96:111]
  v_mfma_f32_32x32x16_bf16 v[112:127], v[24:27], v[28:31], v[112:127]
  v_mfma_f32_32x32x16_bf16 v[80:95], v[32:35], v[44:47], v[80:95]
  v_mfma_f32_32x32x16_bf16 v[96:111], v[36:39], v[44:47], v[96:111]
  v_mfma_f32_32x32x16_bf16 v[112:127], v[40:43], v[44:47], v[112:127]
  s_add_u32 m0, s54, 81920
  s_add_u32 s58, s56, 2752512
  buffer_load_dwordx4 v5, s[40:43], s58 offen offset:0 lds
  buffer_load_dwordx4 v5, s[40:43], s58 offen offset:1024 lds
  buffer_load_dwordx4 v5, s[40:43], s58 offen offset:2048 lds
  s_add_u32 m0, s55, 81920
  s_add_u32 s58, s57, 3584
  buffer_load_dwordx4 v7, s[36:39], s58 offen lds
  buffer_load_dwordx4 v8, s[36:39], s58 offen offset:1024 lds
  s_waitcnt vmcnt(10) lgkmcnt(0)
  s_barrier
  ds_read_b128 v[28:31], v134 offset:0
  ds_read_b128 v[16:19], v10 offset:0
  ds_read_b128 v[20:23], v10 offset:4096
  ds_read_b128 v[24:27], v10 offset:8192
  ds_read_b128 v[44:47], v134 offset:20480
  ds_read_b128 v[32:35], v10 offset:20480
  ds_read_b128 v[36:39], v10 offset:24576
  ds_read_b128 v[40:43], v10 offset:28672
  v_mfma_f32_32x32x16_bf16 v[80:95], v[48:51], v[60:63], v[80:95]
  v_mfma_f32_32x32x16_bf16 v[96:111], v[52:55], v[60:63], v[96:111]
  v_mfma_f32_32x32x16_bf16 v[112:127], v[56:59], v[60:63], v[112:127]
  v_mfma_f32_32x32x16_bf16 v[80:95], v[64:67], v[76:79], v[80:95]
  v_mfma_f32_32x32x16_bf16 v[96:111], v[68:71], v[76:79], v[96:111]
  v_mfma_f32_32x32x16_bf16 v[112:127], v[72:75], v[76:79], v[112:127]
  s_add_u32 m0, s54, 122880
  s_add_u32 s58, s56, 2949120
  buffer_load_dwordx4 v5, s[40:43], s58 offen offset:0 lds
  buffer_load_dwordx4 v5, s[40:43], s58 offen offset:1024 lds
  buffer_load_dwordx4 v5, s[40:43], s58 offen offset:2048 lds
  s_add_u32 m0, s55, 122880
  s_add_u32 s58, s57, 3840
  buffer_load_dwordx4 v7, s[36:39], s58 offen lds
  buffer_load_dwordx4 v8, s[36:39], s58 offen offset:1024 lds
  s_waitcnt vmcnt(10) lgkmcnt(0)
  s_barrier
  ds_read_b128 v[60:63], v135 offset:0
  ds_read_b128 v[48:51], v11 offset:0
  ds_read_b128 v[52:55], v11 offset:4096
  ds_read_b128 v[56:59], v11 offset:8192
  ds_read_b128 v[76:79], v135 offset:20480
  ds_read_b128 v[64:67], v11 offset:20480
  ds_read_b128 v[68:71], v11 offset:24576
  ds_read_b128 v[72:75], v11 offset:28672
  v_mfma_f32_32x32x16_bf16 v[80:95], v[16:19], v[28:31], v[80:95]
  v_mfma_f32_32x32x16_bf16 v[96:111], v[20:23], v[28:31], v[96:111]
  v_mfma_f32_32x32x16_bf16 v[112:127], v[24:27], v[28:31], v[112:127]
  v_mfma_f32_32x32x16_bf16 v[80:95], v[32:35], v[44:47], v[80:95]
  v_mfma_f32_32x32x16_bf16 v[96:111], v[36:39], v[44:47], v[96:111]
  v_mfma_f32_32x32x16_bf16 v[112:127], v[40:43], v[44:47], v[112:127]
  s_waitcnt vmcnt(5) lgkmcnt(0)
  s_barrier
  ds_read_b128 v[28:31], v136 offset:0
  ds_read_b128 v[16:19], v12 offset:0
  ds_read_b128 v[20:23], v12 offset:4096
  ds_read_b128 v[24:27], v12 offset:8192
  ds_read_b128 v[44:47], v136 offset:20480
  ds_read_b128 v[32:35], v12 offset:20480
  ds_read_b128 v[36:39], v12 offset:24576
  ds_read_b128 v[40:43], v12 offset:28672
  v_mfma_f32_32x32x16_bf16 v[80:95], v[48:51], v[60:63], v[80:95]
  v_mfma_f32_32x32x16_bf16 v[96:111], v[52:55], v[60:63], v[96:111]
  v_mfma_f32_32x32x16_bf16 v[112:127], v[56:59], v[60:63], v[112:127]
  v_mfma_f32_32x32x16_bf16 v[80:95], v[64:67], v[76:79], v[80:95]
  v_mfma_f32_32x32x16_bf16 v[96:111], v[68:71], v[76:79], v[96:111]
  v_mfma_f32_32x32x16_bf16 v[112:127], v[72:75], v[76:79], v[112:127]
  s_waitcnt vmcnt(0) lgkmcnt(0)
  s_barrier
  ds_read_b128 v[60:63], v137 offset:0
  ds_read_b128 v[48:51], v13 offset:0
  ds_read_b128 v[52:55], v13 offset:4096
  ds_read_b128 v[56:59], v13 offset:8192
  ds_read_b128 v[76:79], v137 offset:20480
  ds_read_b128 v[64:67], v13 offset:20480
  ds_read_b128 v[68:71], v13 offset:24576
  ds_read_b128 v[72:75], v13 offset:28672
  v_mfma_f32_32x32x16_bf16 v[80:95], v[16:19], v[28:31], v[80:95]
  v_mfma_f32_32x32x16_bf16 v[96:111], v[20:23], v[28:31], v[96:111]
  v_mfma_f32_32x32x16_bf16 v[112:127], v[24:27], v[28:31], v[112:127]
  v_mfma_f32_32x32x16_bf16 v[80:95], v[32:35], v[44:47], v[80:95]
  v_mfma_f32_32x32x16_bf16 v[96:111], v[36:39], v[44:47], v[96:111]
  v_mfma_f32_32x32x16_bf16 v[112:127], v[40:43], v[44:47], v[112:127]
  s_waitcnt lgkmcnt(0)
  v_mfma_f32_32x32x16_bf16 v[80:95], v[48:51], v[60:63], v[80:95]
  v_mfma_f32_32x32x16_bf16 v[96:111], v[52:55], v[60:63], v[96:111]
  v_mfma_f32_32x32x16_bf16 v[112:127], v[56:59], v[60:63], v[112:127]
  v_mfma_f32_32x32x16_bf16 v[80:95], v[64:67], v[76:79], v[80:95]
  v_mfma_f32_32x32x16_bf16 v[96:111], v[68:71], v[76:79], v[96:111]
  v_mfma_f32_32x32x16_bf16 v[112:127], v[72:75], v[76:79], v[112:127]
  s_mov_b32 s32, s24
  s_mov_b32 s33, s25
  s_mov_b32 s34, 704512
  s_mov_b32 s35, 0x00020000
  s_sub_u32 s68, s7, 0
  s_cmp_ge_u32 s68, 6
  s_cbranch_scc1 pf7
  s_lshl_b32 s68, s68, 12
  v_lshlrev_b32 v138, 6, v2
  v_add_u32 v138, s68, v138
  s_lshr_b32 s69, s2, 3
  s_mul_i32 s69, s69, 24576
  buffer_load_dword v139, v138, s[32:35], s69 offen
pf7:
  s_mul_i32 s59, s7, 12288
  v_add_u32 v10, s59, v5
  s_mul_i32 s59, s50, 12288
  s_add_u32 s59, s59, s53
  v_add_u32 v11, s59, v5
  v_add_u32 v12, 49152, v11
  v_lshlrev_b32 v9, 16, v9
  s_nop 7
  s_barrier
  ds_write_b128 v10, v[80:83] offset:0
  ds_write_b128 v10, v[84:87] offset:1024
  ds_write_b128 v10, v[88:91] offset:2048
  ds_write_b128 v10, v[92:95] offset:3072
  ds_write_b128 v10, v[96:99] offset:4096
  ds_write_b128 v10, v[100:103] offset:5120
  ds_write_b128 v10, v[104:107] offset:6144
  ds_write_b128 v10, v[108:111] offset:7168
  ds_write_b128 v10, v[112:115] offset:8192
  ds_write_b128 v10, v[116:119] offset:9216
  ds_write_b128 v10, v[120:123] offset:10240
  ds_write_b128 v10, v[124:127] offset:11264
  s_waitcnt lgkmcnt(0)
  s_barrier
  ds_read_b128 v[16:19], v11 offset:0
  ds_read_b128 v[20:23], v11 offset:24576
  ds_read_b128 v[24:27], v12 offset:0
  ds_read_b128 v[28:31], v12 offset:24576
  ds_read_b128 v[32:35], v11 offset:1024
  ds_read_b128 v[36:39], v11 offset:25600
  ds_read_b128 v[40:43], v12 offset:1024
  ds_read_b128 v[44:47], v12 offset:25600
  ds_read_b128 v[48:51], v11 offset:2048
  ds_read_b128 v[52:55], v11 offset:26624
  ds_read_b128 v[56:59], v12 offset:2048
  ds_read_b128 v[60:63], v12 offset:26624
  s_waitcnt lgkmcnt(8)
  v_pk_add_f32 v[16:17], v[16:17], v[24:25]
  v_pk_add_f32 v[18:19], v[18:19], v[26:27]
  v_pk_add_f32 v[20:21], v[20:21], v[28:29]
  v_pk_add_f32 v[22:23], v[22:23], v[30:31]
  v_pk_add_f32 v[16:17], v[16:17], v[20:21]
  v_pk_add_f32 v[18:19], v[18:19], v[22:23]
  v_lshlrev_b32 v20, 16, v128
  v_and_b32 v21, 0xffff0000, v128
  v_lshlrev_b32 v22, 16, v129
  v_and_b32 v23, 0xffff0000, v129
  v_add_f32 v16, v16, v9
  v_add_f32 v17, v17, v9
  v_add_f32 v18, v18, v9
  v_add_f32 v19, v19, v9
  v_mul_f32 v16, v16, v20
  v_mul_f32 v17, v17, v21
  v_mul_f32 v18, v18, v22
  v_mul_f32 v19, v19, v23
  v_cvt_pk_bf16_f32 v24, v16, v17
  v_cvt_pk_bf16_f32 v25, v18, v19
  buffer_store_dwordx2 v[24:25], v5, s[40:43], s64 offen
  s_waitcnt lgkmcnt(4)
  v_pk_add_f32 v[32:33], v[32:33], v[40:41]
  v_pk_add_f32 v[34:35], v[34:35], v[42:43]
  v_pk_add_f32 v[36:37], v[36:37], v[44:45]
  v_pk_add_f32 v[38:39], v[38:39], v[46:47]
  v_pk_add_f32 v[32:33], v[32:33], v[36:37]
  v_pk_add_f32 v[34:35], v[34:35], v[38:39]
  v_lshlrev_b32 v36, 16, v130
  v_and_b32 v37, 0xffff0000, v130
  v_lshlrev_b32 v38, 16, v131
  v_and_b32 v39, 0xffff0000, v131
  v_add_f32 v32, v32, v9
  v_add_f32 v33, v33, v9
  v_add_f32 v34, v34, v9
  v_add_f32 v35, v35, v9
  v_mul_f32 v32, v32, v36
  v_mul_f32 v33, v33, v37
  v_mul_f32 v34, v34, v38
  v_mul_f32 v35, v35, v39
  v_cvt_pk_bf16_f32 v40, v32, v33
  v_cvt_pk_bf16_f32 v41, v34, v35
  buffer_store_dwordx2 v[40:41], v5, s[40:43], s65 offen
  s_waitcnt lgkmcnt(0)
  v_pk_add_f32 v[48:49], v[48:49], v[56:57]
  v_pk_add_f32 v[50:51], v[50:51], v[58:59]
  v_pk_add_f32 v[52:53], v[52:53], v[60:61]
  v_pk_add_f32 v[54:55], v[54:55], v[62:63]
  v_pk_add_f32 v[48:49], v[48:49], v[52:53]
  v_pk_add_f32 v[50:51], v[50:51], v[54:55]
  v_lshlrev_b32 v52, 16, v132
  v_and_b32 v53, 0xffff0000, v132
  v_lshlrev_b32 v54, 16, v133
  v_and_b32 v55, 0xffff0000, v133
  v_add_f32 v48, v48, v9
  v_add_f32 v49, v49, v9
  v_add_f32 v50, v50, v9
  v_add_f32 v51, v51, v9
  v_mul_f32 v48, v48, v52
  v_mul_f32 v49, v49, v53
  v_mul_f32 v50, v50, v54
  v_mul_f32 v51, v51, v55
  v_cvt_pk_bf16_f32 v56, v48, v49
  v_cvt_pk_bf16_f32 v57, v50, v51
  buffer_store_dwordx2 v[56:57], v5, s[40:43], s66 offen
kc1_kernel_end:
  s_endpgm
.globl kc2_kernel
.p2align 8
.type kc2_kernel,@function
kc2_kernel:
  s_cmp_ge_u32 s2, 256
  s_cbranch_scc1 kc2_kernel_end
  s_load_dwordx16 s[8:23], s[0:1], 0
  s_load_dwordx8 s[24:31], s[0:1], 64
  s_and_b32 s3, s2, 7
  s_lshr_b32 s4, s2, 3
  s_lshl_b32 s5, s3, 2
  s_lshr_b32 s6, s4, 3
  s_add_u32 s5, s5, s6
  s_and_b32 s6, s4, 7
  v_lshrrev_b32 v1, 6, v0
  v_and_b32 v2, 63, v0
  v_readfirstlane_b32 s7, v1
  v_and_b32 v3, 31, v0
  v_bfe_u32 v4, v0, 5, 1
  s_waitcnt lgkmcnt(0)
  s_mov_b32 s32, s26
  s_mov_b32 s33, s27
  s_mov_b32 s34, 2097152
  s_mov_b32 s35, 0x00020000
  s_mov_b32 s36, s24
  s_mov_b32 s37, s25
  s_mov_b32 s38, 704512
  s_mov_b32 s39, 0x00020000
  s_mov_b32 s40, s30
  s_mov_b32 s41, s31
  s_mov_b32 s42, 268435456
  s_mov_b32 s43, 0x00020000
  s_and_b32 s49, s7, 1
  s_lshr_b32 s48, s7, 1
  s_lshl_b32 s57, s5, 1
  s_add_u32 s57, s57, s49
  s_mul_i32 s57, s57, 48
  s_mul_i32 s58, s48, 11
  s_add_u32 s57, s57, s58
  s_lshl_b32 s57, s57, 10
  s_add_u32 s57, s57, 16777216
  v_lshlrev_b32 v6, 4, v2
  s_mul_i32 s50, s7, 90112
  s_lshl_b32 s51, s6, 7
  s_add_u32 s50, s50, s51
  s_mul_i32 s51, s7, 11264
  v_lshrrev_b32 v8, 3, v2
  v_lshlrev_b32 v8, 10, v8
  v_bfe_u32 v9, v2, 4, 1
  v_lshlrev_b32 v9, 2, v9
  v_and_b32 v10, 7, v2
  v_xor_b32 v9, v9, v10
  v_lshl_add_u32 v8, v9, 4, v8
  s_add_u32 m0, s51, 0
  s_add_u32 s52, s50, 0
  buffer_load_dwordx4 v8, s[36:39], s52 offen lds
  s_add_u32 m0, s51, 1024
  s_add_u32 s52, s50, 8192
  buffer_load_dwordx4 v8, s[36:39], s52 offen lds
  s_add_u32 m0, s51, 2048
  s_add_u32 s52, s50, 16384
  buffer_load_dwordx4 v8, s[36:39], s52 offen lds
  s_add_u32 m0, s51, 3072
  s_add_u32 s52, s50, 24576
  buffer_load_dwordx4 v8, s[36:39], s52 offen lds
  s_add_u32 m0, s51, 4096
  s_add_u32 s52, s50, 32768
  buffer_load_dwordx4 v8, s[36:39], s52 offen lds
  s_add_u32 m0, s51, 5120
  s_add_u32 s52, s50, 40960
  buffer_load_dwordx4 v8, s[36:39], s52 offen lds
  s_add_u32 m0, s51, 6144
  s_add_u32 s52, s50, 49152
  buffer_load_dwordx4 v8, s[36:39], s52 offen lds
  s_add_u32 m0, s51, 7168
  s_add_u32 s52, s50, 57344
  buffer_load_dwordx4 v8, s[36:39], s52 offen lds
  s_add_u32 m0, s51, 8192
  s_add_u32 s52, s50, 65536
  buffer_load_dwordx4 v8, s[36:39], s52 offen lds
  s_add_u32 m0, s51, 9216
  s_add_u32 s52, s50, 73728
  buffer_load_dwordx4 v8, s[36:39], s52 offen lds
  s_add_u32 m0, s51, 10240
  s_add_u32 s52, s50, 81920
  buffer_load_dwordx4 v8, s[36:39], s52 offen lds
  v_mov_b32 v184, v6
  buffer_load_dwordx4 v[16:19], v184, s[40:43], s57 offen offset:0
  buffer_load_dwordx4 v[20:23], v184, s[40:43], s57 offen offset:1024
  s_lshl_b32 s53, s5, 16
  s_lshl_b32 s54, s6, 7
  s_add_u32 s53, s53, s54
  s_add_u32 s54, s53, 5242880
  v_lshrrev_b32 v5, 3, v0
  v_and_b32 v6, 7, v0
  v_lshlrev_b32 v7, 10, v5
  v_lshl_add_u32 v7, v6, 4, v7
  buffer_load_dwordx4 v[12:15], v7, s[40:43], s54 offen
  v_bfe_u32 v8, v2, 2, 2
  v_mad_u32_u24 v11, v4, 4, v8
  v_mul_u32_u24 v11, 128, v11
  v_bfe_u32 v9, v2, 4, 1
  v_lshlrev_b32 v9, 5, v9
  v_and_b32 v8, 3, v2
  v_lshl_add_u32 v9, v8, 3, v9
  v_bfe_u32 v8, v2, 3, 1
  v_lshlrev_b32 v8, 6, v8
  v_xor_b32 v9, v8, v9
  v_add_u32 v11, v11, v9
  s_mul_i32 s56, s48, 22528
  v_add_u32 v11, s56, v11
  v_xor_b32 v10, 64, v11
  s_waitcnt vmcnt(3)
  s_barrier
  ds_read_b64_tr_b16 v[64:65], v11 offset:0
  ds_read_b64_tr_b16 v[66:67], v11 offset:1024
  ds_read_b64_tr_b16 v[68:69], v10 offset:0
  ds_read_b64_tr_b16 v[70:71], v10 offset:1024
  ds_read_b64_tr_b16 v[72:73], v11 offset:2048
  ds_read_b64_tr_b16 v[74:75], v11 offset:3072
  ds_read_b64_tr_b16 v[76:77], v10 offset:2048
  ds_read_b64_tr_b16 v[78:79], v10 offset:3072
  ds_read_b64_tr_b16 v[80:81], v11 offset:4096
  ds_read_b64_tr_b16 v[82:83], v11 offset:5120
  ds_read_b64_tr_b16 v[84:85], v10 offset:4096
  ds_read_b64_tr_b16 v[86:87], v10 offset:5120
  buffer_load_dwordx4 v[24:27], v184, s[40:43], s57 offen offset:2048
  buffer_load_dwordx4 v[28:31], v184, s[40:43], s57 offen offset:3072
  s_add_u32 s57, s57, 4096
  buffer_load_dwordx4 v[32:35], v184, s[40:43], s57 offen offset:0
  buffer_load_dwordx4 v[36:39], v184, s[40:43], s57 offen offset:1024
  buffer_load_dwordx4 v[40:43], v184, s[40:43], s57 offen offset:2048
  ds_read_b64_tr_b16 v[88:89], v11 offset:6144
  ds_read_b64_tr_b16 v[90:91], v11 offset:7168
  ds_read_b64_tr_b16 v[92:93], v10 offset:6144
  ds_read_b64_tr_b16 v[94:95], v10 offset:7168
  s_waitcnt vmcnt(5) lgkmcnt(12)
  v_mfma_f32_32x32x16_bf16 v[152:167], v[64:67], v[16:19], 0
  v_mfma_f32_32x32x16_bf16 v[168:183], v[68:71], v[16:19], 0
  buffer_load_dwordx4 v[44:47], v184, s[40:43], s57 offen offset:3072
  s_add_u32 s57, s57, 4096
  ds_read_b64_tr_b16 v[96:97], v11 offset:8192
  ds_read_b64_tr_b16 v[98:99], v11 offset:9216
  ds_read_b64_tr_b16 v[100:101], v10 offset:8192
  ds_read_b64_tr_b16 v[102:103], v10 offset:9216
  s_waitcnt vmcnt(6) lgkmcnt(12)
  v_mfma_f32_32x32x16_bf16 v[152:167], v[72:75], v[20:23], v[152:167]
  v_mfma_f32_32x32x16_bf16 v[168:183], v[76:79], v[20:23], v[168:183]
  buffer_load_dwordx4 v[48:51], v184, s[40:43], s57 offen offset:0
  ds_read_b64_tr_b16 v[104:105], v11 offset:10240
  ds_read_b64_tr_b16 v[106:107], v11 offset:11264
  ds_read_b64_tr_b16 v[108:109], v10 offset:10240
  ds_read_b64_tr_b16 v[110:111], v10 offset:11264
  s_waitcnt vmcnt(6) lgkmcnt(12)
  v_mfma_f32_32x32x16_bf16 v[152:167], v[80:83], v[24:27], v[152:167]
  v_mfma_f32_32x32x16_bf16 v[168:183], v[84:87], v[24:27], v[168:183]
  buffer_load_dwordx4 v[52:55], v184, s[40:43], s57 offen offset:1024
  ds_read_b64_tr_b16 v[112:113], v11 offset:12288
  ds_read_b64_tr_b16 v[114:115], v11 offset:13312
  ds_read_b64_tr_b16 v[116:117], v10 offset:12288
  ds_read_b64_tr_b16 v[118:119], v10 offset:13312
  s_waitcnt vmcnt(6) lgkmcnt(12)
  v_mfma_f32_32x32x16_bf16 v[152:167], v[88:91], v[28:31], v[152:167]
  v_mfma_f32_32x32x16_bf16 v[168:183], v[92:95], v[28:31], v[168:183]
  buffer_load_dwordx4 v[56:59], v184, s[40:43], s57 offen offset:2048
  ds_read_b64_tr_b16 v[120:121], v11 offset:14336
  ds_read_b64_tr_b16 v[122:123], v11 offset:15360
  ds_read_b64_tr_b16 v[124:125], v10 offset:14336
  ds_read_b64_tr_b16 v[126:127], v10 offset:15360
  s_waitcnt vmcnt(6) lgkmcnt(12)
  v_mfma_f32_32x32x16_bf16 v[152:167], v[96:99], v[32:35], v[152:167]
  v_mfma_f32_32x32x16_bf16 v[168:183], v[100:103], v[32:35], v[168:183]
  ds_read_b64_tr_b16 v[128:129], v11 offset:16384
  ds_read_b64_tr_b16 v[130:131], v11 offset:17408
  ds_read_b64_tr_b16 v[132:133], v10 offset:16384
  ds_read_b64_tr_b16 v[134:135], v10 offset:17408
  s_waitcnt vmcnt(5) lgkmcnt(12)
  v_mfma_f32_32x32x16_bf16 v[152:167], v[104:107], v[36:39], v[152:167]
  v_mfma_f32_32x32x16_bf16 v[168:183], v[108:111], v[36:39], v[168:183]
  ds_read_b64_tr_b16 v[136:137], v11 offset:18432
  ds_read_b64_tr_b16 v[138:139], v11 offset:19456
  ds_read_b64_tr_b16 v[140:141], v10 offset:18432
  ds_read_b64_tr_b16 v[142:143], v10 offset:19456
  s_waitcnt vmcnt(4) lgkmcnt(12)
  v_mfma_f32_32x32x16_bf16 v[152:167], v[112:115], v[40:43], v[152:167]
  v_mfma_f32_32x32x16_bf16 v[168:183], v[116:119], v[40:43], v[168:183]
  ds_read_b64_tr_b16 v[144:145], v11 offset:20480
  ds_read_b64_tr_b16 v[146:147], v11 offset:21504
  ds_read_b64_tr_b16 v[148:149], v10 offset:20480
  ds_read_b64_tr_b16 v[150:151], v10 offset:21504
  s_waitcnt vmcnt(3) lgkmcnt(12)
  v_mfma_f32_32x32x16_bf16 v[152:167], v[120:123], v[44:47], v[152:167]
  v_mfma_f32_32x32x16_bf16 v[168:183], v[124:127], v[44:47], v[168:183]
  s_waitcnt vmcnt(2) lgkmcnt(8)
  v_mfma_f32_32x32x16_bf16 v[152:167], v[128:131], v[48:51], v[152:167]
  v_mfma_f32_32x32x16_bf16 v[168:183], v[132:135], v[48:51], v[168:183]
  s_waitcnt vmcnt(1) lgkmcnt(4)
  v_mfma_f32_32x32x16_bf16 v[152:167], v[136:139], v[52:55], v[152:167]
  v_mfma_f32_32x32x16_bf16 v[168:183], v[140:143], v[52:55], v[168:183]
  s_waitcnt vmcnt(0) lgkmcnt(0)
  v_mfma_f32_32x32x16_bf16 v[152:167], v[144:147], v[56:59], v[152:167]
  v_mfma_f32_32x32x16_bf16 v[168:183], v[148:151], v[56:59], v[168:183]
  s_mul_i32 s56, s48, 17408
  s_mul_i32 s57, s49, 8704
  s_add_u32 s56, s56, s57
  s_add_u32 s56, s56, 90112
  v_mul_u32_u24 v8, 272, v3
  v_lshl_add_u32 v8, v4, 4, v8
  v_add_u32 v8, s56, v8
  v_mul_u32_u24 v9, 272, v5
  v_lshl_add_u32 v9, v6, 5, v9
  v_add_u32 v9, 90112, v9
  s_add_u32 s54, s53, 0
  s_nop 7
  ds_write_b128 v8, v[152:155] offset:0
  ds_write_b128 v8, v[156:159] offset:32
  ds_write_b128 v8, v[160:163] offset:64
  ds_write_b128 v8, v[164:167] offset:96
  ds_write_b128 v8, v[168:171] offset:128
  ds_write_b128 v8, v[172:175] offset:160
  ds_write_b128 v8, v[176:179] offset:192
  ds_write_b128 v8, v[180:183] offset:224
  s_waitcnt lgkmcnt(0)
  s_barrier
  ds_read_b128 v[16:19], v9 offset:0
  ds_read_b128 v[20:23], v9 offset:16
  ds_read_b128 v[24:27], v9 offset:17408
  ds_read_b128 v[28:31], v9 offset:17424
  ds_read_b128 v[32:35], v9 offset:34816
  ds_read_b128 v[36:39], v9 offset:34832
  ds_read_b128 v[40:43], v9 offset:52224
  ds_read_b128 v[44:47], v9 offset:52240
  v_lshlrev_b32 v48, 16, v12
  v_and_b32 v49, 0xffff0000, v12
  v_lshlrev_b32 v50, 16, v13
  v_and_b32 v51, 0xffff0000, v13
  v_lshlrev_b32 v52, 16, v14
  v_and_b32 v53, 0xffff0000, v14
  v_lshlrev_b32 v54, 16, v15
  v_and_b32 v55, 0xffff0000, v15
  s_waitcnt lgkmcnt(0)
  v_pk_add_f32 v[16:17], v[16:17], v[24:25]
  v_pk_add_f32 v[18:19], v[18:19], v[26:27]
  v_pk_add_f32 v[20:21], v[20:21], v[28:29]
  v_pk_add_f32 v[22:23], v[22:23], v[30:31]
  v_pk_add_f32 v[32:33], v[32:33], v[40:41]
  v_pk_add_f32 v[34:35], v[34:35], v[42:43]
  v_pk_add_f32 v[36:37], v[36:37], v[44:45]
  v_pk_add_f32 v[38:39], v[38:39], v[46:47]
  v_pk_add_f32 v[16:17], v[16:17], v[32:33]
  v_pk_add_f32 v[18:19], v[18:19], v[34:35]
  v_pk_add_f32 v[20:21], v[20:21], v[36:37]
  v_pk_add_f32 v[22:23], v[22:23], v[38:39]
  v_pk_add_f32 v[16:17], v[16:17], v[48:49]
  v_pk_add_f32 v[18:19], v[18:19], v[50:51]
  v_pk_add_f32 v[20:21], v[20:21], v[52:53]
  v_pk_add_f32 v[22:23], v[22:23], v[54:55]
  v_cvt_pk_bf16_f32 v24, v16, v17
  v_cvt_pk_bf16_f32 v25, v18, v19
  v_cvt_pk_bf16_f32 v26, v20, v21
  v_cvt_pk_bf16_f32 v27, v22, v23
  buffer_store_dwordx4 v[24:27], v7, s[32:35], s54 offen
kc2_kernel_end:
  s_endpgm
.section .rodata,"a"
.p2align 6
.amdhsa_kernel ka_kernel
  .amdhsa_next_free_vgpr 152
  .amdhsa_next_free_sgpr 102
  .amdhsa_accum_offset 152
  .amdhsa_group_segment_fixed_size 0
  .amdhsa_kernarg_size 96
  .amdhsa_user_sgpr_count 2
  .amdhsa_user_sgpr_kernarg_segment_ptr 1
  .amdhsa_system_sgpr_workgroup_id_x 1
.end_amdhsa_kernel
.p2align 6
.amdhsa_kernel kb1_kernel
  .amdhsa_next_free_vgpr 164
  .amdhsa_next_free_sgpr 102
  .amdhsa_accum_offset 164
  .amdhsa_group_segment_fixed_size 0
  .amdhsa_kernarg_size 96
  .amdhsa_user_sgpr_count 2
  .amdhsa_user_sgpr_kernarg_segment_ptr 1
  .amdhsa_system_sgpr_workgroup_id_x 1
.end_amdhsa_kernel
.p2align 6
.amdhsa_kernel kb2_kernel
  .amdhsa_next_free_vgpr 152
  .amdhsa_next_free_sgpr 102
  .amdhsa_accum_offset 152
  .amdhsa_group_segment_fixed_size 0
  .amdhsa_kernarg_size 96
  .amdhsa_user_sgpr_count 2
  .amdhsa_user_sgpr_kernarg_segment_ptr 1
  .amdhsa_system_sgpr_workgroup_id_x 1
.end_amdhsa_kernel
.p2align 6
.amdhsa_kernel kc1_kernel
  .amdhsa_next_free_vgpr 144
  .amdhsa_next_free_sgpr 102
  .amdhsa_accum_offset 144
  .amdhsa_group_segment_fixed_size 0
  .amdhsa_kernarg_size 96
  .amdhsa_user_sgpr_count 2
  .amdhsa_user_sgpr_kernarg_segment_ptr 1
  .amdhsa_system_sgpr_workgroup_id_x 1
.end_amdhsa_kernel
.p2align 6
.amdhsa_kernel kc2_kernel
  .amdhsa_next_free_vgpr 192
  .amdhsa_next_free_sgpr 102
  .amdhsa_accum_offset 192
  .amdhsa_group_segment_fixed_size 0
  .amdhsa_kernarg_size 96
  .amdhsa_user_sgpr_count 2
  .amdhsa_user_sgpr_kernarg_segment_ptr 1
  .amdhsa_system_sgpr_workgroup_id_x 1
.end_amdhsa_kernel
```
